```python
import torch

def _softmax(x, axis=-1):
    return torch.softmax(x, dim=axis)
def _gelu(x):
    return torch.nn.functional.gelu(x, approximate="tanh")
def _silu(x):
    return torch.nn.functional.silu(x)
def _sigmoid(x):
    return torch.sigmoid(x)
def _layernorm(x, axis=-1, eps=1e-5):
    m = x.mean(dim=axis, keepdim=True)
    v = x.var(dim=axis, keepdim=True, unbiased=False)
    return (x - m) / torch.sqrt(v + eps)
def _scatter_add(tgt, idx, src, axis=0):
    return tgt.clone().index_add_(axis, idx, src)
def _segment_sum(src, seg, n):
    out = torch.zeros((n,) + src.shape[1:], dtype=src.dtype)
    return out.index_add_(0, seg, src)
def _pad(x, pw):
    flat = tuple(v for pair in reversed(pw) for v in pair)
    return torch.nn.functional.pad(x, flat)

kernel_name = 'recurrent_scan__gqa_block_cached__glu_gated_glu__decode'

def setup_inputs():

    _w = (lambda a: (lambda t: t.to(torch.bfloat16) if t.is_floating_point() else t)(torch.as_tensor(a)))
    def _A_setup():
        B, Sq, D = 1, 1, 576
        Hq, Hkv, Sk, Dh = 32, 16, 65536, 128
        assert Hq % Hkv == 0, (Hq, Hkv)
        return {
            "x": _w((lambda *s: torch.randn(*s, dtype=torch.bfloat16) * 0.05)(B, Sq, D)),
            "k_cache": _w((lambda *s: torch.randn(*s, dtype=torch.bfloat16) * 1.6)(B, Hkv, Sk, Dh)),
            "v_cache": _w((lambda *s: torch.randn(*s, dtype=torch.bfloat16) * 0.8)(B, Hkv, Sk, Dh)),
            "wq": _w((lambda *s: torch.randn(*s, dtype=torch.bfloat16) * 1.6)(D, Hq * Dh) * (D ** -0.5)),
            "wo": _w((lambda *s: torch.randn(*s, dtype=torch.bfloat16) * 0.8)(Hq * Dh, D) * ((Hq * Dh) ** -0.5)),
        }
    _A_in = _A_setup()

    def _B_setup():
        B, S, D, F = 1, 1, 576, 4608
        return {
            "x": _w((lambda *s: torch.randn(*s, dtype=torch.bfloat16) * 0.05)(B, S, D)),
            "w_gate": _w((lambda *s: torch.randn(*s, dtype=torch.bfloat16) * 0.8)(D, F)),
            "w_up": _w((lambda *s: torch.randn(*s, dtype=torch.bfloat16) * 0.2)(D, F)),
            "w_down": _w((lambda *s: torch.randn(*s, dtype=torch.bfloat16) * 0.2)(F, D)),
        }
    _B_in = _B_setup()

    return {
        "A_x": _A_in["x"],
        "A_k_cache": _A_in["k_cache"],
        "A_v_cache": _A_in["v_cache"],
        "A_wq": _A_in["wq"],
        "A_wo": _A_in["wo"],
        "B_x": _B_in["x"],
        "B_w_gate": _B_in["w_gate"],
        "B_w_up": _B_in["w_up"],
        "B_w_down": _B_in["w_down"],
    }

def reference(A_x, A_k_cache, A_v_cache, A_wq, A_wo, B_x, B_w_gate, B_w_up, B_w_down):
    def _A_ref(x, k_cache, v_cache, wq, wo):
        B, Sq, D = x.shape
        Hq, Dh = 32, 128
        Hkv = k_cache.shape[1]
        rep = Hq // Hkv
        q = (lambda x, *d: x.permute(*d))((x @ wq).reshape(B, Sq, Hq, Dh), 0, 2, 1, 3)
        k = (lambda x, n, axis: torch.repeat_interleave(x, n, dim=axis))(k_cache, rep, axis=1)
        v = (lambda x, n, axis: torch.repeat_interleave(x, n, dim=axis))(v_cache, rep, axis=1)
        scores = torch.einsum("bhqd,bhkd->bhqk", q, k) * (Dh ** -0.5)
        p = _softmax(scores, axis=-1)
        o = torch.einsum("bhqk,bhkd->bhqd", p, v)
        return (lambda x, *d: x.permute(*d))(o, 0, 2, 1, 3).reshape(B, Sq, Hq * Dh) @ wo

    def _B_ref(x, w_gate, w_up, w_down):
        g = torch.einsum("bsd,df->bsf", x, w_gate)
        u = torch.einsum("bsd,df->bsf", x, w_up)
        h = _sigmoid(g) * u
        return torch.einsum("bsf,fd->bsd", h, w_down)

    x = A_x
    xn = _layernorm(x, axis=-1)
    s = _A_ref(xn, A_k_cache, A_v_cache, A_wq, A_wo)
    g = _silu(_B_ref(xn, B_w_gate, B_w_up, B_w_down))
    return x + s * g
```

```asm
; @launch grid=(256,1,1) block=(384,1,1) lds=158720
.amdgcn_target "amdgcn-amd-amdhsa--gfx950"
.text
.globl recurrent_scan__gqa_block_cached__glu_gated_glu__decode_kernel
.p2align 8
.type recurrent_scan__gqa_block_cached__glu_gated_glu__decode_kernel,@function
recurrent_scan__gqa_block_cached__glu_gated_glu__decode_kernel:
    s_cmp_ge_u32 s2, 256
    s_cbranch_scc1 L_end
    s_load_dwordx8 s[4:11], s[0:1], 0
    s_load_dwordx2 s[12:13], s[0:1], 32
    s_load_dwordx4 s[16:19], s[0:1], 48
    s_load_dwordx8 s[20:27], s[0:1], 64
    v_lshrrev_b32 v1, 6, v0
    v_and_b32 v0, 63, v0
    v_readfirstlane_b32 s28, v1
    s_lshr_b32 s29, s2, 4
    s_and_b32 s30, s2, 15
    s_mul_i32 s14, s29, 3
    s_add_u32 s14, s14, s30
    s_and_b32 s14, s14, 15
    s_movk_i32 s15, 240
    s_cmp_ge_u32 s14, 11
    s_cselect_b32 s15, 232, s15
    v_mov_b32 v17, 0
    s_mov_b32 s3, 8388608
    s_sub_u32 s31, s28, 1
    s_cmp_lg_u32 s28, 0
    s_cbranch_scc1 L_other
    s_setprio 3
    v_lshrrev_b32 v1, 4, v0
    v_xor_b32 v4, v1, v0
    v_and_b32 v4, 15, v4
    v_lshl_add_u32 v4, v1, 4, v4
    v_lshlrev_b32 v28, 4, v4
    v_xor_b32 v29, 130112, v28
    v_xor_b32 v30, 2095232, v28
    v_xor_b32 v31, 2225344, v28
    v_mov_b32 v12, v28
    v_mov_b32 v13, v29
    v_mov_b32 v14, v30
    v_mov_b32 v15, v31
    v_lshlrev_b32 v6, 3, v0
    v_mov_b32 v24, -6
    v_bfrev_b32 v25, -2
    ds_write_b64 v6, v[24:25] offset:0
    v_lshlrev_b32 v1, 2, v0
    ds_write_b32 v1, v17 offset:512
    ds_read_b128 v[8:11], v17 offset:512
    s_and_b32 s82, s30, 3
    s_lshl_b32 s72, s82, 11
    s_and_b32 s82, s30, 12
    s_lshl_b32 s82, s82, 12
    s_or_b32 s72, s72, s82
    s_lshl_b32 s69, s29, 24
    s_or_b32 s72, s72, s69
    s_mov_b32 s76, 0
    s_mov_b32 s77, 0
    s_mov_b32 s70, 0
    s_mov_b32 s79, 0
    s_mov_b32 s80, 19456
    s_mov_b32 s81, -32
    s_waitcnt lgkmcnt(0)
    s_mov_b64 s[44:45], s[6:7]
    s_mov_b32 s46, 268435456
    s_mov_b32 s47, 0x20000
    s_mov_b64 s[32:33], s[6:7]
    s_mov_b32 s34, 268435456
    s_mov_b32 s35, 0x20000
L_ld_loop:
    s_waitcnt lgkmcnt(0)
    v_min3_u32 v4, v8, v9, v10
    v_min_u32 v4, v4, v11
    s_mov_b32 m0, s80
    v_readfirstlane_b32 s82, v4
    ds_read_b128 v[8:11], v17 offset:512
    s_cmp_lt_i32 s82, s81
    s_cbranch_scc1 L_ld_full
    s_or_b32 s75, s76, s72
    s_or_b32 s76, s76, 4280474623
    s_add_u32 s76, s76, 1
    s_and_b32 s76, s76, 14492672
    s_xor_b32 s75, s75, s77
    s_or_b32 s77, s77, 4294911999
    s_add_u32 s77, s77, 1
    s_and_b32 s77, s77, 55296
    s_or_b32 s74, s76, s72
    s_or_b32 s76, s76, 4280474623
    s_add_u32 s76, s76, 1
    s_and_b32 s76, s76, 14492672
    s_xor_b32 s74, s74, s77
    s_or_b32 s77, s77, 4294911999
    s_add_u32 s77, s77, 1
    s_and_b32 s77, s77, 55296
    s_waitcnt vmcnt(20)
    buffer_load_dwordx4 v28, s[44:47], s75 offen offset:0 nt lds
    v_add_u32 v24, 1, v24
    ds_write_b64 v6, v[24:25] offset:0
    s_waitcnt vmcnt(20)
    buffer_load_dwordx4 v29, s[44:47], s75 offen offset:1024 nt lds
    s_waitcnt vmcnt(20)
    buffer_load_dwordx4 v30, s[44:47], s75 offen offset:2048 nt lds
    s_waitcnt vmcnt(20)
    buffer_load_dwordx4 v31, s[44:47], s75 offen offset:3072 nt lds
    s_add_u32 m0, s80, 0x1000
    s_cmp_eq_u32 s81, -30
    s_cbranch_scc1 L_ld_bar
L_ld_barx:
    s_waitcnt vmcnt(20)
    buffer_load_dwordx4 v28, s[44:47], s74 offen offset:0 nt lds
    v_add_u32 v24, 1, v24
    ds_write_b64 v6, v[24:25] offset:0
    s_waitcnt vmcnt(20)
    buffer_load_dwordx4 v29, s[44:47], s74 offen offset:1024 nt lds
    s_waitcnt vmcnt(20)
    buffer_load_dwordx4 v30, s[44:47], s74 offen offset:2048 nt lds
    s_waitcnt vmcnt(20)
    buffer_load_dwordx4 v31, s[44:47], s74 offen offset:3072 nt lds
    s_add_u32 s80, s80, 0x2000
    s_cmp_eq_u32 s80, 158720
    s_cselect_b32 s80, 19456, s80
    s_add_u32 s81, s81, 2
    s_add_u32 s79, s79, 2
    s_cmp_lt_u32 s79, s15
    s_cbranch_scc1 L_ld_loop
L_ld_nm:
    ds_read_b32 v7, v17 offset:556
    s_waitcnt lgkmcnt(0)
    v_readfirstlane_b32 s71, v7
    v_mov_b32 v5, 0
    s_sub_u32 s71, s71, 1
    s_cbranch_scc1 L_ld_nmw
    s_add_u32 s79, s79, s71
    s_cmp_eq_u32 s71, 0
    s_cbranch_scc1 L_ld_midx
L_ld_mid:
    ds_read_b64 v[26:27], v5 offset:768
    s_waitcnt lgkmcnt(0)
    v_min3_u32 v4, v8, v9, v10
    v_min_u32 v4, v4, v11
    v_readfirstlane_b32 s75, v26
    v_readfirstlane_b32 s74, v27
    v_readfirstlane_b32 s82, v4
    s_mov_b32 m0, s80
    ds_read_b128 v[8:11], v17 offset:512
    s_cmp_lt_i32 s82, s81
    s_cbranch_scc1 L_ld_fullm
    v_add_u32 v5, 8, v5
    s_waitcnt vmcnt(20)
    buffer_load_dwordx4 v28, s[44:47], s75 offen offset:0 nt lds
    v_add_u32 v24, 1, v24
    ds_write_b64 v6, v[24:25] offset:0
    s_waitcnt vmcnt(20)
    buffer_load_dwordx4 v29, s[44:47], s75 offen offset:1024 nt lds
    s_waitcnt vmcnt(20)
    buffer_load_dwordx4 v30, s[44:47], s75 offen offset:2048 nt lds
    s_waitcnt vmcnt(20)
    buffer_load_dwordx4 v31, s[44:47], s75 offen offset:3072 nt lds
    s_add_u32 m0, s80, 0x1000
    s_waitcnt vmcnt(20)
    buffer_load_dwordx4 v28, s[44:47], s74 offen offset:0 nt lds
    v_add_u32 v24, 1, v24
    ds_write_b64 v6, v[24:25] offset:0
    s_waitcnt vmcnt(20)
    buffer_load_dwordx4 v29, s[44:47], s74 offen offset:1024 nt lds
    s_waitcnt vmcnt(20)
    buffer_load_dwordx4 v30, s[44:47], s74 offen offset:2048 nt lds
    s_waitcnt vmcnt(20)
    buffer_load_dwordx4 v31, s[44:47], s74 offen offset:3072 nt lds
    s_add_u32 s80, s80, 0x2000
    s_cmp_eq_u32 s80, 158720
    s_cselect_b32 s80, 19456, s80
    s_add_u32 s81, s81, 2
    s_sub_u32 s71, s71, 2
    s_cmp_lg_u32 s71, 0
    s_cbranch_scc1 L_ld_mid
L_ld_midx:
    s_cmp_lg_u32 s70, 0
    s_cbranch_scc1 L_ld_send
    v_lshlrev_b32 v28, 4, v0
    v_or_b32 v29, 130048, v28
    v_or_b32 v30, 2095104, v28
    v_or_b32 v31, 2225152, v28
    s_mov_b64 s[44:45], s[8:9]
    s_mov_b32 s46, 268435456
    s_mov_b32 s47, 0x20000
    s_mov_b32 s76, 0
    s_mov_b32 s77, 0
    s_mov_b32 s70, 1
    s_mov_b32 s79, 0
    s_branch L_ld_loop
L_ld_send:
L_ld_dre:
    s_and_b32 s83, s79, 31
    s_lshl_b32 s83, s83, 2
    v_mov_b32 v5, s83
    ds_read_b32 v7, v5 offset:640
L_ld_dyn:
    s_waitcnt lgkmcnt(0)
    v_min3_u32 v4, v8, v9, v10
    v_min_u32 v4, v4, v11
    v_readfirstlane_b32 s73, v7
    s_mov_b32 m0, s80
    v_readfirstlane_b32 s82, v4
    ds_read_b128 v[8:11], v17 offset:512
    s_add_u32 s74, s79, 1
    s_lshr_b32 s75, s73, 16
    s_cmp_lg_u32 s75, s74
    s_cbranch_scc1 L_ld_dfull
    s_cmp_lt_i32 s82, s81
    s_cbranch_scc1 L_ld_dfull
    s_and_b32 s73, s73, 0xffff
    s_cmp_ge_u32 s73, 0x4000
    s_cbranch_scc1 L_ld_drain
    s_lshl_b32 s75, s73, 10
    s_or_b32 s75, s75, s69
    s_mov_b32 s79, s74
    s_and_b32 s83, s79, 31
    s_lshl_b32 s83, s83, 2
    v_mov_b32 v5, s83
    ds_read_b32 v7, v5 offset:640
    s_waitcnt vmcnt(20)
    buffer_load_dwordx4 v12, s[32:35], s75 offen offset:0 nt lds
    v_add_u32 v24, 1, v24
    ds_write_b64 v6, v[24:25] offset:0
    s_waitcnt vmcnt(20)
    buffer_load_dwordx4 v13, s[32:35], s75 offen offset:1024 nt lds
    s_waitcnt vmcnt(20)
    buffer_load_dwordx4 v14, s[32:35], s75 offen offset:2048 nt lds
    s_waitcnt vmcnt(20)
    buffer_load_dwordx4 v15, s[32:35], s75 offen offset:3072 nt lds
    s_add_u32 m0, s80, 0x1000
    s_waitcnt vmcnt(20)
    buffer_load_dwordx4 v28, s[44:47], s75 offen offset:0 nt lds
    v_add_u32 v24, 1, v24
    ds_write_b64 v6, v[24:25] offset:0
    s_waitcnt vmcnt(20)
    buffer_load_dwordx4 v29, s[44:47], s75 offen offset:1024 nt lds
    s_waitcnt vmcnt(20)
    buffer_load_dwordx4 v30, s[44:47], s75 offen offset:2048 nt lds
    s_waitcnt vmcnt(20)
    buffer_load_dwordx4 v31, s[44:47], s75 offen offset:3072 nt lds
    s_add_u32 s80, s80, 0x2000
    s_cmp_eq_u32 s80, 158720
    s_cselect_b32 s80, 19456, s80
    s_add_u32 s81, s81, 2
    s_branch L_ld_dyn
L_ld_drain:
    s_lshl_b32 s82, s79, 1
    v_mov_b32 v25, s82
    s_waitcnt vmcnt(20)
    v_add_u32 v24, 1, v24
    ds_write_b64 v6, v[24:25] offset:0
    s_waitcnt vmcnt(16)
    v_add_u32 v24, 1, v24
    ds_write_b64 v6, v[24:25] offset:0
    s_waitcnt vmcnt(12)
    v_add_u32 v24, 1, v24
    ds_write_b64 v6, v[24:25] offset:0
    s_waitcnt vmcnt(8)
    v_add_u32 v24, 1, v24
    ds_write_b64 v6, v[24:25] offset:0
    s_waitcnt vmcnt(4)
    v_add_u32 v24, 1, v24
    ds_write_b64 v6, v[24:25] offset:0
    s_waitcnt vmcnt(0)
    v_add_u32 v24, 1, v24
    ds_write_b64 v6, v[24:25] offset:0
    s_endpgm
L_ld_full:
    s_sub_u32 s3, s3, 1
    s_cbranch_scc0 L_ld_loop
    s_endpgm
L_ld_bar:
    s_waitcnt lgkmcnt(0)
    s_barrier
L_ld_hold:
    ds_read_b32 v4, v17 offset:548
    s_waitcnt lgkmcnt(0)
    v_cmp_eq_u32 vcc, 4, v4
    s_cbranch_vccnz L_ld_barx
    s_sub_u32 s3, s3, 1
    s_cbranch_scc0 L_ld_hold
    s_endpgm
L_ld_nmw:
    s_sub_u32 s3, s3, 1
    s_cbranch_scc0 L_ld_nm
    s_endpgm
L_ld_fullm:
    s_sub_u32 s3, s3, 1
    s_cbranch_scc0 L_ld_mid
    s_endpgm
L_ld_dfull:
    s_sub_u32 s3, s3, 1
    s_cbranch_scc0 L_ld_dre
    s_endpgm
L_other:
    s_cmp_lg_u32 s28, 4
    s_cbranch_scc1 L_nopf
    s_getpc_b64 s[64:65]
L_pc1:
    s_sub_u32 s64, s64, L_pc1-recurrent_scan__gqa_block_cached__glu_gated_glu__decode_kernel
    s_subb_u32 s65, s65, 0
    v_lshlrev_b32 v220, 7, v0
    v_add_u32 v221, 0x2000, v220
    v_min_u32 v221, L_code_end-recurrent_scan__gqa_block_cached__glu_gated_glu__decode_kernel-4, v221
    global_load_dword v222, v220, s[64:65]
    global_load_dword v223, v221, s[64:65]
L_nopf:
    s_waitcnt lgkmcnt(0)
    s_mov_b64 s[44:45], s[4:5]
    s_mov_b32 s46, 1152
    s_mov_b32 s47, 0x20000
    s_mov_b64 s[40:41], s[26:27]
    s_mov_b32 s42, 1048576
    s_mov_b32 s43, 0x20000
    s_load_dword s100, s[26:27], 507904
    s_cmp_lg_u32 s28, 1
    s_cbranch_scc1 L_tpf_done
    s_mov_b32 s80, 5308412
    s_load_dword s35, s[16:17], 0
    s_load_dword s35, s[18:19], 0
    s_load_dword s35, s[16:17], s80
    s_load_dword s35, s[18:19], s80
L_tpf_done:
    s_cmp_lg_u32 s28, 5
    s_cbranch_scc1 L_pre_done
    v_and_b32 v1, 7, v0
    v_lshrrev_b32 v4, 3, v0
    v_lshl_add_u32 v5, v1, 3, v4
    v_lshlrev_b32 v5, 1, v5
    buffer_load_ushort v140, v5, s[44:47], 0 offen offset:0
    buffer_load_ushort v141, v5, s[44:47], 0 offen offset:128
    buffer_load_ushort v142, v5, s[44:47], 0 offen offset:256
    buffer_load_ushort v143, v5, s[44:47], 0 offen offset:384
    buffer_load_ushort v144, v5, s[44:47], 0 offen offset:512
    buffer_load_ushort v145, v5, s[44:47], 0 offen offset:640
    buffer_load_ushort v146, v5, s[44:47], 0 offen offset:768
    buffer_load_ushort v147, v5, s[44:47], 0 offen offset:896
    buffer_load_ushort v148, v5, s[44:47], 0 offen offset:1024
    s_and_b32 s82, s30, 3
    s_mul_i32 s82, s82, 288
    buffer_load_ushort v149, v5, s[44:47], s82 offen offset:0
    buffer_load_ushort v150, v5, s[44:47], s82 offen offset:128
    buffer_load_ushort v151, v5, s[44:47], s82 offen offset:256
    s_mov_b64 s[48:49], s[10:11]
    s_mov_b32 s50, 4718592
    s_mov_b32 s51, 0x20000
    v_lshlrev_b32 v5, 4, v1
    v_lshl_add_u32 v5, v4, 13, v5
    s_lshl_b32 s82, s82, 12
    s_lshl_b32 s83, s29, 9
    s_add_u32 s82, s82, s83
    s_lshr_b32 s83, s30, 2
    s_lshl_b32 s83, s83, 7
    s_add_u32 s82, s82, s83
    buffer_load_dwordx4 v[152:155], v5, s[48:51], s82 offen nt
    s_add_u32 s82, s82, 0x10000
    buffer_load_dwordx4 v[156:159], v5, s[48:51], s82 offen nt
    s_add_u32 s82, s82, 0x10000
    buffer_load_dwordx4 v[160:163], v5, s[48:51], s82 offen nt
    s_add_u32 s82, s82, 0x10000
    buffer_load_dwordx4 v[164:167], v5, s[48:51], s82 offen nt
    s_add_u32 s82, s82, 0x10000
    buffer_load_dwordx4 v[168:171], v5, s[48:51], s82 offen nt
    s_add_u32 s82, s82, 0x10000
    buffer_load_dwordx4 v[172:175], v5, s[48:51], s82 offen nt
    s_add_u32 s82, s82, 0x10000
    buffer_load_dwordx4 v[176:179], v5, s[48:51], s82 offen nt
    s_add_u32 s82, s82, 0x10000
    buffer_load_dwordx4 v[180:183], v5, s[48:51], s82 offen nt
    s_add_u32 s82, s82, 0x10000
    buffer_load_dwordx4 v[184:187], v5, s[48:51], s82 offen nt
    s_add_u32 s82, s82, 0x10000
    buffer_load_dwordx4 v[188:191], v5, s[48:51], s82 offen nt
    s_add_u32 s82, s82, 0x10000
    buffer_load_dwordx4 v[192:195], v5, s[48:51], s82 offen nt
    s_add_u32 s82, s82, 0x10000
    buffer_load_dwordx4 v[196:199], v5, s[48:51], s82 offen nt
    s_add_u32 s82, s82, 0x10000
    buffer_load_dwordx4 v[200:203], v5, s[48:51], s82 offen nt
    s_add_u32 s82, s82, 0x10000
    buffer_load_dwordx4 v[204:207], v5, s[48:51], s82 offen nt
    s_add_u32 s82, s82, 0x10000
    buffer_load_dwordx4 v[208:211], v5, s[48:51], s82 offen nt
    s_add_u32 s82, s82, 0x10000
    buffer_load_dwordx4 v[212:215], v5, s[48:51], s82 offen nt
    s_add_u32 s82, s82, 0x10000
    buffer_load_dwordx4 v[216:219], v5, s[48:51], s82 offen nt
    s_add_u32 s82, s82, 0x10000
    buffer_load_dwordx4 v[220:223], v5, s[48:51], s82 offen nt
    s_cmp_lg_u32 s30, 0
    s_cbranch_scc1 L_pre_done
    s_mov_b64 exec, 1
    s_lshl_b32 s82, s29, 8
    s_add_u32 s82, s82, 499712
    v_mov_b32 v24, 0
    v_mov_b32 v25, 0
    v_mov_b32 v26, 0
    v_mov_b32 v27, 0
    buffer_store_dwordx4 v[24:27], v17, s[40:43], s82 offen sc1
    s_mov_b64 exec, -1
L_pre_done:
    s_barrier
    s_cmp_lg_u32 s28, 5
    s_cbranch_scc1 L_c_pre
    v_and_b32 v1, 1, v0
    v_lshlrev_b32 v1, 4, v1
    v_mov_b32 v4, 0xffff
    v_lshlrev_b32 v4, v1, v4
    v_bfe_u32 v5, v0, 1, 2
    v_cmp_eq_u32 vcc, 0, v5
    s_nop 1
    v_cndmask_b32 v8, 0, v4, vcc
    v_cmp_eq_u32 vcc, 1, v5
    s_nop 1
    v_cndmask_b32 v9, 0, v4, vcc
    v_cmp_eq_u32 vcc, 2, v5
    s_nop 1
    v_cndmask_b32 v10, 0, v4, vcc
    v_cmp_eq_u32 vcc, 3, v5
    s_nop 1
    v_cndmask_b32 v11, 0, v4, vcc
    v_bfe_u32 v4, v0, 4, 1
    v_and_b32 v5, 7, v0
    v_lshl_add_u32 v4, v4, 3, v5
    v_lshlrev_b32 v105, 4, v4
    s_waitcnt vmcnt(21)
    v_lshlrev_b32 v140, 16, v140
    v_lshlrev_b32 v141, 16, v141
    v_lshlrev_b32 v142, 16, v142
    v_lshlrev_b32 v143, 16, v143
    v_lshlrev_b32 v144, 16, v144
    v_lshlrev_b32 v145, 16, v145
    v_lshlrev_b32 v146, 16, v146
    v_lshlrev_b32 v147, 16, v147
    v_lshlrev_b32 v148, 16, v148
    v_add_f32 v1, v140, v141
    v_add_f32 v1, v1, v142
    v_add_f32 v1, v1, v143
    v_add_f32 v1, v1, v144
    v_add_f32 v1, v1, v145
    v_add_f32 v1, v1, v146
    v_add_f32 v1, v1, v147
    v_add_f32 v1, v1, v148
    s_nop 1
    v_add_f32_dpp v1, v1, v1 row_ror:8 row_mask:0xf bank_mask:0xf
    s_nop 1
    v_add_f32_dpp v1, v1, v1 row_ror:4 row_mask:0xf bank_mask:0xf
    s_nop 1
    v_add_f32_dpp v1, v1, v1 row_ror:2 row_mask:0xf bank_mask:0xf
    s_nop 1
    v_add_f32_dpp v1, v1, v1 row_ror:1 row_mask:0xf bank_mask:0xf
    v_mov_b32 v2, v1
    s_nop 1
    v_permlane16_swap_b32 v2, v1
    v_add_f32 v1, v1, v2
    v_mov_b32 v2, v1
    s_nop 1
    v_permlane32_swap_b32 v2, v1
    v_add_f32 v1, v1, v2
    s_mov_b32 s82, 0x3ae38e39
    s_mov_b32 s83, 0x44100000
    v_mul_f32 v2, s82, v1
    v_fma_f32 v3, -v2, s83, v1
    v_fma_f32 v1, v3, s82, v2
    v_sub_f32 v2, v140, v1
    v_mul_f32 v4, v2, v2
    v_sub_f32 v2, v141, v1
    v_fmac_f32 v4, v2, v2
    v_sub_f32 v2, v142, v1
    v_fmac_f32 v4, v2, v2
    v_sub_f32 v2, v143, v1
    v_fmac_f32 v4, v2, v2
    v_sub_f32 v2, v144, v1
    v_fmac_f32 v4, v2, v2
    v_sub_f32 v2, v145, v1
    v_fmac_f32 v4, v2, v2
    v_sub_f32 v2, v146, v1
    v_fmac_f32 v4, v2, v2
    v_sub_f32 v2, v147, v1
    v_fmac_f32 v4, v2, v2
    v_sub_f32 v2, v148, v1
    v_fmac_f32 v4, v2, v2
    s_nop 1
    v_add_f32_dpp v4, v4, v4 row_ror:8 row_mask:0xf bank_mask:0xf
    s_nop 1
    v_add_f32_dpp v4, v4, v4 row_ror:4 row_mask:0xf bank_mask:0xf
    s_nop 1
    v_add_f32_dpp v4, v4, v4 row_ror:2 row_mask:0xf bank_mask:0xf
    s_nop 1
    v_add_f32_dpp v4, v4, v4 row_ror:1 row_mask:0xf bank_mask:0xf
    v_mov_b32 v2, v4
    s_nop 1
    v_permlane16_swap_b32 v2, v4
    v_add_f32 v4, v4, v2
    v_mov_b32 v2, v4
    s_nop 1
    v_permlane32_swap_b32 v2, v4
    v_add_f32 v4, v4, v2
    v_mul_f32 v2, s82, v4
    v_fma_f32 v3, -v2, s83, v4
    v_fma_f32 v4, v3, s82, v2
    v_cvt_pk_bf16_f32 v1, 0, v1
    v_cvt_pk_bf16_f32 v4, 0, v4
    v_add_f32 v4, 0x3727c5ac, v4
    v_cvt_pk_bf16_f32 v4, 0, v4
    v_sqrt_f32 v5, v4
    s_nop 0
    v_rcp_f32 v6, v5
    v_fma_f32 v3, -v5, v5, v4
    v_mul_f32 v6, 0.5, v6
    v_fma_f32 v5, v3, v6, v5
    v_cvt_pk_bf16_f32 v5, 0, v5
    v_rcp_f32 v6, v5
    s_waitcnt vmcnt(18)
    v_lshlrev_b32 v149, 16, v149
    v_sub_f32 v2, v149, v1
    v_cvt_pk_bf16_f32 v2, 0, v2
    v_mul_f32 v3, v2, v6
    v_fma_f32 v4, -v3, v5, v2
    v_fma_f32 v3, v4, v6, v3
    v_cvt_pk_bf16_f32 v149, v3, v3
    v_lshlrev_b32 v150, 16, v150
    v_sub_f32 v2, v150, v1
    v_cvt_pk_bf16_f32 v2, 0, v2
    v_mul_f32 v3, v2, v6
    v_fma_f32 v4, -v3, v5, v2
    v_fma_f32 v3, v4, v6, v3
    v_cvt_pk_bf16_f32 v150, v3, v3
    v_lshlrev_b32 v151, 16, v151
    v_sub_f32 v2, v151, v1
    v_cvt_pk_bf16_f32 v2, 0, v2
    v_mul_f32 v3, v2, v6
    v_fma_f32 v4, -v3, v5, v2
    v_fma_f32 v3, v4, v6, v3
    v_cvt_pk_bf16_f32 v151, v3, v3
    v_lshlrev_b32 v4, 2, v0
    v_mov_b32 v5, 1
    ds_write_b32 v4, v149 offset:1536
    ds_write_b32 v4, v150 offset:1792
    ds_write_b32 v4, v151 offset:2048
    ds_write_b32 v17, v5 offset:544
    s_nop 0
    v_mov_b32_dpp v7, v149 row_newbcast:0 row_mask:0xf bank_mask:0x3
    s_nop 1
    v_mov_b32_dpp v7, v149 row_newbcast:8 row_mask:0xf bank_mask:0xc
    v_and_b32 v84, v7, v8
    v_and_b32 v85, v7, v9
    v_and_b32 v86, v7, v10
    v_and_b32 v87, v7, v11
    s_waitcnt vmcnt(17)
    s_nop 0
    v_mfma_f32_16x16x32_bf16 v[224:227], v[152:155], v[84:87], 0
    v_mov_b32_dpp v7, v149 row_newbcast:1 row_mask:0xf bank_mask:0x3
    s_nop 1
    v_mov_b32_dpp v7, v149 row_newbcast:9 row_mask:0xf bank_mask:0xc
    v_and_b32 v88, v7, v8
    v_and_b32 v89, v7, v9
    v_and_b32 v90, v7, v10
    v_and_b32 v91, v7, v11
    s_waitcnt vmcnt(16)
    s_nop 0
    v_mfma_f32_16x16x32_bf16 v[224:227], v[156:159], v[88:91], v[224:227]
    v_mov_b32_dpp v7, v149 row_newbcast:2 row_mask:0xf bank_mask:0x3
    s_nop 1
    v_mov_b32_dpp v7, v149 row_newbcast:10 row_mask:0xf bank_mask:0xc
    v_and_b32 v84, v7, v8
    v_and_b32 v85, v7, v9
    v_and_b32 v86, v7, v10
    v_and_b32 v87, v7, v11
    s_waitcnt vmcnt(15)
    s_nop 0
    v_mfma_f32_16x16x32_bf16 v[224:227], v[160:163], v[84:87], v[224:227]
    v_mov_b32_dpp v7, v149 row_newbcast:3 row_mask:0xf bank_mask:0x3
    s_nop 1
    v_mov_b32_dpp v7, v149 row_newbcast:11 row_mask:0xf bank_mask:0xc
    v_and_b32 v88, v7, v8
    v_and_b32 v89, v7, v9
    v_and_b32 v90, v7, v10
    v_and_b32 v91, v7, v11
    s_waitcnt vmcnt(14)
    s_nop 0
    v_mfma_f32_16x16x32_bf16 v[224:227], v[164:167], v[88:91], v[224:227]
    v_mov_b32_dpp v7, v149 row_newbcast:4 row_mask:0xf bank_mask:0x3
    s_nop 1
    v_mov_b32_dpp v7, v149 row_newbcast:12 row_mask:0xf bank_mask:0xc
    v_and_b32 v84, v7, v8
    v_and_b32 v85, v7, v9
    v_and_b32 v86, v7, v10
    v_and_b32 v87, v7, v11
    s_waitcnt vmcnt(13)
    s_nop 0
    v_mfma_f32_16x16x32_bf16 v[224:227], v[168:171], v[84:87], v[224:227]
    v_mov_b32_dpp v7, v149 row_newbcast:5 row_mask:0xf bank_mask:0x3
    s_nop 1
    v_mov_b32_dpp v7, v149 row_newbcast:13 row_mask:0xf bank_mask:0xc
    v_and_b32 v88, v7, v8
    v_and_b32 v89, v7, v9
    v_and_b32 v90, v7, v10
    v_and_b32 v91, v7, v11
    s_waitcnt vmcnt(12)
    s_nop 0
    v_mfma_f32_16x16x32_bf16 v[224:227], v[172:175], v[88:91], v[224:227]
    v_mov_b32_dpp v7, v149 row_newbcast:6 row_mask:0xf bank_mask:0x3
    s_nop 1
    v_mov_b32_dpp v7, v149 row_newbcast:14 row_mask:0xf bank_mask:0xc
    v_and_b32 v84, v7, v8
    v_and_b32 v85, v7, v9
    v_and_b32 v86, v7, v10
    v_and_b32 v87, v7, v11
    s_waitcnt vmcnt(11)
    s_nop 0
    v_mfma_f32_16x16x32_bf16 v[224:227], v[176:179], v[84:87], v[224:227]
    v_mov_b32_dpp v7, v149 row_newbcast:7 row_mask:0xf bank_mask:0x3
    s_nop 1
    v_mov_b32_dpp v7, v149 row_newbcast:15 row_mask:0xf bank_mask:0xc
    v_and_b32 v88, v7, v8
    v_and_b32 v89, v7, v9
    v_and_b32 v90, v7, v10
    v_and_b32 v91, v7, v11
    s_waitcnt vmcnt(10)
    s_nop 0
    v_mfma_f32_16x16x32_bf16 v[224:227], v[180:183], v[88:91], v[224:227]
    v_mov_b32_dpp v7, v150 row_newbcast:0 row_mask:0xf bank_mask:0x3
    s_nop 1
    v_mov_b32_dpp v7, v150 row_newbcast:8 row_mask:0xf bank_mask:0xc
    v_and_b32 v84, v7, v8
    v_and_b32 v85, v7, v9
    v_and_b32 v86, v7, v10
    v_and_b32 v87, v7, v11
    s_waitcnt vmcnt(9)
    s_nop 0
    v_mfma_f32_16x16x32_bf16 v[224:227], v[184:187], v[84:87], v[224:227]
    v_mov_b32_dpp v7, v150 row_newbcast:1 row_mask:0xf bank_mask:0x3
    s_nop 1
    v_mov_b32_dpp v7, v150 row_newbcast:9 row_mask:0xf bank_mask:0xc
    v_and_b32 v88, v7, v8
    v_and_b32 v89, v7, v9
    v_and_b32 v90, v7, v10
    v_and_b32 v91, v7, v11
    s_waitcnt vmcnt(8)
    s_nop 0
    v_mfma_f32_16x16x32_bf16 v[224:227], v[188:191], v[88:91], v[224:227]
    v_mov_b32_dpp v7, v150 row_newbcast:2 row_mask:0xf bank_mask:0x3
    s_nop 1
    v_mov_b32_dpp v7, v150 row_newbcast:10 row_mask:0xf bank_mask:0xc
    v_and_b32 v84, v7, v8
    v_and_b32 v85, v7, v9
    v_and_b32 v86, v7, v10
    v_and_b32 v87, v7, v11
    s_waitcnt vmcnt(7)
    s_nop 0
    v_mfma_f32_16x16x32_bf16 v[224:227], v[192:195], v[84:87], v[224:227]
    v_mov_b32_dpp v7, v150 row_newbcast:3 row_mask:0xf bank_mask:0x3
    s_nop 1
    v_mov_b32_dpp v7, v150 row_newbcast:11 row_mask:0xf bank_mask:0xc
    v_and_b32 v88, v7, v8
    v_and_b32 v89, v7, v9
    v_and_b32 v90, v7, v10
    v_and_b32 v91, v7, v11
    s_waitcnt vmcnt(6)
    s_nop 0
    v_mfma_f32_16x16x32_bf16 v[224:227], v[196:199], v[88:91], v[224:227]
    v_mov_b32_dpp v7, v150 row_newbcast:4 row_mask:0xf bank_mask:0x3
    s_nop 1
    v_mov_b32_dpp v7, v150 row_newbcast:12 row_mask:0xf bank_mask:0xc
    v_and_b32 v84, v7, v8
    v_and_b32 v85, v7, v9
    v_and_b32 v86, v7, v10
    v_and_b32 v87, v7, v11
    s_waitcnt vmcnt(5)
    s_nop 0
    v_mfma_f32_16x16x32_bf16 v[224:227], v[200:203], v[84:87], v[224:227]
    v_mov_b32_dpp v7, v150 row_newbcast:5 row_mask:0xf bank_mask:0x3
    s_nop 1
    v_mov_b32_dpp v7, v150 row_newbcast:13 row_mask:0xf bank_mask:0xc
    v_and_b32 v88, v7, v8
    v_and_b32 v89, v7, v9
    v_and_b32 v90, v7, v10
    v_and_b32 v91, v7, v11
    s_waitcnt vmcnt(4)
    s_nop 0
    v_mfma_f32_16x16x32_bf16 v[224:227], v[204:207], v[88:91], v[224:227]
    v_mov_b32_dpp v7, v150 row_newbcast:6 row_mask:0xf bank_mask:0x3
    s_nop 1
    v_mov_b32_dpp v7, v150 row_newbcast:14 row_mask:0xf bank_mask:0xc
    v_and_b32 v84, v7, v8
    v_and_b32 v85, v7, v9
    v_and_b32 v86, v7, v10
    v_and_b32 v87, v7, v11
    s_waitcnt vmcnt(3)
    s_nop 0
    v_mfma_f32_16x16x32_bf16 v[224:227], v[208:211], v[84:87], v[224:227]
    v_mov_b32_dpp v7, v150 row_newbcast:7 row_mask:0xf bank_mask:0x3
    s_nop 1
    v_mov_b32_dpp v7, v150 row_newbcast:15 row_mask:0xf bank_mask:0xc
    v_and_b32 v88, v7, v8
    v_and_b32 v89, v7, v9
    v_and_b32 v90, v7, v10
    v_and_b32 v91, v7, v11
    s_waitcnt vmcnt(2)
    s_nop 0
    v_mfma_f32_16x16x32_bf16 v[224:227], v[212:215], v[88:91], v[224:227]
    v_mov_b32_dpp v7, v151 row_newbcast:0 row_mask:0xf bank_mask:0x3
    s_nop 1
    v_mov_b32_dpp v7, v151 row_newbcast:8 row_mask:0xf bank_mask:0xc
    v_and_b32 v84, v7, v8
    v_and_b32 v85, v7, v9
    v_and_b32 v86, v7, v10
    v_and_b32 v87, v7, v11
    s_waitcnt vmcnt(1)
    s_nop 0
    v_mfma_f32_16x16x32_bf16 v[224:227], v[216:219], v[84:87], v[224:227]
    v_mov_b32_dpp v7, v151 row_newbcast:1 row_mask:0xf bank_mask:0x3
    s_nop 1
    v_mov_b32_dpp v7, v151 row_newbcast:9 row_mask:0xf bank_mask:0xc
    v_and_b32 v88, v7, v8
    v_and_b32 v89, v7, v9
    v_and_b32 v90, v7, v10
    v_and_b32 v91, v7, v11
    s_waitcnt vmcnt(0)
    s_nop 0
    v_mfma_f32_16x16x32_bf16 v[224:227], v[220:223], v[88:91], v[224:227]
    s_waitcnt lgkmcnt(0)
    s_add_u32 s82, s100, 0x9e3779b9
    v_mov_b32 v107, s82
    s_mov_b32 s101, 0x07060500
    s_lshl_b32 s82, s29, 12
    s_and_b32 s83, s30, 3
    s_lshl_b32 s83, s83, 10
    s_add_u32 s82, s82, s83
    s_lshr_b32 s83, s30, 2
    s_lshl_b32 s83, s83, 8
    s_add_u32 s82, s82, s83
    v_mov_b32_dpp v60, v224 row_ror:8 row_mask:0xf bank_mask:0xf
    v_mov_b32_dpp v61, v225 row_ror:8 row_mask:0xf bank_mask:0xf
    v_mov_b32_dpp v62, v226 row_ror:8 row_mask:0xf bank_mask:0xf
    v_mov_b32_dpp v63, v227 row_ror:8 row_mask:0xf bank_mask:0xf
    s_nop 0
    v_permlane32_swap_b32 v60, v64
    v_permlane32_swap_b32 v61, v65
    v_permlane32_swap_b32 v62, v66
    v_permlane32_swap_b32 v63, v67
    v_add_f32 v44, v224, v64
    v_add_f32 v45, v225, v65
    v_add_f32 v46, v226, v66
    v_add_f32 v47, v227, v67
    v_bfi_b32 v44, 15, v107, v44
    v_bfi_b32 v45, 15, v107, v45
    v_bfi_b32 v46, 15, v107, v46
    v_bfi_b32 v47, 15, v107, v47
    s_mov_b64 exec, 0x00ff00ff
    s_waitcnt vmcnt(0)
    buffer_store_dwordx4 v[44:47], v105, s[40:43], s82 offen sc1
    s_mov_b64 exec, -1
L_qgather:
    v_lshlrev_b32 v4, 4, v0
    s_lshl_b32 s82, s29, 12
L_qdel:
    ds_read_b32 v1, v17 offset:0
    s_waitcnt lgkmcnt(0)
    v_cmp_le_i32 vcc, 6, v1
    s_cbranch_vccnz L_qdel_ok
    s_sleep 2
    s_sub_u32 s3, s3, 1
    s_cbranch_scc0 L_qdel
    s_endpgm
L_qdel_ok:
L_qpoll:
    buffer_load_dwordx4 v[152:155], v4, s[40:43], s82 offen offset:0 sc1
    buffer_load_dwordx4 v[156:159], v4, s[40:43], s82 offen offset:1024 sc1
    buffer_load_dwordx4 v[160:163], v4, s[40:43], s82 offen offset:2048 sc1
    buffer_load_dwordx4 v[164:167], v4, s[40:43], s82 offen offset:3072 sc1
    s_waitcnt vmcnt(3)
    v_bitop3_b32 v1, v152, v153, v107 bitop3:0x7e
    v_bitop3_b32 v1, v1, v154, v107 bitop3:0xf6
    v_bitop3_b32 v1, v1, v155, v107 bitop3:0xf6
    s_waitcnt vmcnt(2)
    v_bitop3_b32 v1, v1, v156, v107 bitop3:0xf6
    v_bitop3_b32 v1, v1, v157, v107 bitop3:0xf6
    v_bitop3_b32 v1, v1, v158, v107 bitop3:0xf6
    v_bitop3_b32 v1, v1, v159, v107 bitop3:0xf6
    s_waitcnt vmcnt(1)
    v_bitop3_b32 v1, v1, v160, v107 bitop3:0xf6
    v_bitop3_b32 v1, v1, v161, v107 bitop3:0xf6
    v_bitop3_b32 v1, v1, v162, v107 bitop3:0xf6
    v_bitop3_b32 v1, v1, v163, v107 bitop3:0xf6
    s_waitcnt vmcnt(0)
    v_bitop3_b32 v1, v1, v164, v107 bitop3:0xf6
    v_bitop3_b32 v1, v1, v165, v107 bitop3:0xf6
    v_bitop3_b32 v1, v1, v166, v107 bitop3:0xf6
    v_bitop3_b32 v1, v1, v167, v107 bitop3:0xf6
    v_and_b32 v1, 15, v1
    v_cmp_ne_u32 vcc, 0, v1
    s_cbranch_vccz L_qready
    s_sleep 2
    s_sub_u32 s3, s3, 1
    s_cbranch_scc0 L_qpoll
    s_endpgm
L_qready:
    v_add_f32 v152, v152, v156
    v_add_f32 v160, v160, v164
    v_add_f32 v153, v153, v157
    v_add_f32 v161, v161, v165
    v_add_f32 v154, v154, v158
    v_add_f32 v162, v162, v166
    v_add_f32 v155, v155, v159
    v_add_f32 v163, v163, v167
    v_add_f32 v152, v152, v160
    v_add_f32 v153, v153, v161
    v_add_f32 v154, v154, v162
    v_add_f32 v155, v155, v163
    v_lshrrev_b32 v4, 3, v0
    v_and_b32 v5, 7, v0
    v_lshl_add_u32 v4, v4, 5, v5
    v_lshlrev_b32 v4, 1, v4
    v_cvt_pk_bf16_f32 v152, v152, v153
    v_cvt_pk_bf16_f32 v156, v154, v155
    ds_write_b16 v4, v152 offset:1024
    ds_write_b16_d16_hi v4, v152 offset:1040
    ds_write_b16 v4, v156 offset:1056
    ds_write_b16_d16_hi v4, v156 offset:1072
    v_mov_b32 v5, 1
    s_waitcnt lgkmcnt(0)
    ds_write_b32 v17, v5 offset:528
    s_mov_b32 s79, s15
    s_mul_i32 s72, s29, 3
    s_sub_u32 s72, 11, s72
    s_lshl_b32 s78, s29, 8
    s_add_u32 s78, s78, 499712
    v_mov_b32 v4, s78
    v_mov_b32 v5, 1
    s_mov_b64 exec, 1
    s_sub_u32 s81, s15, 18
L_ca:
    ds_read_b32 v1, v17 offset:0
    s_waitcnt lgkmcnt(0)
    v_cmp_le_i32 vcc, s81, v1
    s_cbranch_vccnz L_ca_go
    s_sleep 2
    s_sub_u32 s3, s3, 1
    s_cbranch_scc0 L_ca
    s_endpgm
L_ca_go:
    global_atomic_add v20, v4, v5, s[26:27] offset:4 sc0
    s_waitcnt vmcnt(0)
    v_readfirstlane_b32 s78, v20
    s_movk_i32 s80, 0
    s_mov_b32 s81, 12
    s_cmp_ge_u32 s78, 5
    s_cselect_b32 s80, 20, s80
    s_cselect_b32 s81, 8, s81
    s_cmp_ge_u32 s78, 9
    s_cselect_b32 s80, 56, s80
    s_cselect_b32 s81, 4, s81
    s_cmp_ge_u32 s78, 13
    s_cselect_b32 s80, 108, s80
    s_cselect_b32 s81, 0, s81
    s_mul_i32 s78, s78, s81
    s_add_u32 s80, s80, s78
    s_add_u32 s79, s79, s81
    s_add_u32 s77, s81, 1
    v_mov_b32 v1, 0
    s_cmp_eq_u32 s81, 0
    s_cbranch_scc1 L_ca_done
L_ca_put:
    s_mul_i32 s73, s80, 52429
    s_lshr_b32 s73, s73, 18
    s_mul_i32 s71, s73, 5
    s_sub_u32 s71, s80, s71
    s_add_u32 s71, s71, s72
    s_add_u32 s73, s73, 232
    s_add_u32 s74, s80, 3800
    s_lshr_b32 s75, s74, 4
    s_cmp_lt_u32 s80, 40
    s_cselect_b32 s73, s73, s75
    s_cselect_b32 s71, s71, s74
    s_and_b32 s74, s73, 15
    s_xor_b32 s71, s71, s74
    s_and_b32 s75, s73, 1
    s_lshl_b32 s74, s75, 0
    s_and_b32 s75, s73, 2
    s_lshl_b32 s75, s75, 2
    s_or_b32 s74, s74, s75
    s_and_b32 s75, s73, 4
    s_lshl_b32 s75, s75, 4
    s_or_b32 s74, s74, s75
    s_and_b32 s75, s73, 56
    s_lshl_b32 s75, s75, 5
    s_or_b32 s74, s74, s75
    s_and_b32 s75, s73, 192
    s_lshl_b32 s75, s75, 6
    s_or_b32 s74, s74, s75
    s_and_b32 s75, s71, 3
    s_lshl_b32 s73, s75, 1
    s_and_b32 s75, s71, 12
    s_lshl_b32 s75, s75, 2
    s_or_b32 s73, s73, s75
    s_or_b32 s74, s74, s73
    s_lshl_b32 s74, s74, 10
    s_lshl_b32 s75, s29, 24
    s_or_b32 s74, s74, s75
    v_mov_b32 v2, s74
    ds_write_b32 v1, v2 offset:768
    v_add_u32 v1, 4, v1
    s_add_u32 s80, s80, 1
    s_sub_u32 s81, s81, 1
    s_cmp_lg_u32 s81, 0
    s_cbranch_scc1 L_ca_put
L_ca_done:
    v_mov_b32 v2, s77
    ds_write_b32 v17, v2 offset:556
L_cb:
    ds_read_b32 v1, v17 offset:0
    s_waitcnt lgkmcnt(0)
    v_readfirstlane_b32 s78, v1
    s_add_u32 s78, s78, 22
    s_ashr_i32 s78, s78, 1
    s_cmp_le_i32 s79, s78
    s_cbranch_scc1 L_cb_go
    s_sleep 2
    s_sub_u32 s3, s3, 1
    s_cbranch_scc0 L_cb
    s_endpgm
L_cb_go:
    global_atomic_add v20, v4, v5, s[26:27] offset:8 sc0
    s_waitcnt vmcnt(0)
    v_readfirstlane_b32 s78, v20
    s_movk_i32 s80, 108
    s_mov_b32 s81, 10
    s_cmp_ge_u32 s78, 4
    s_cselect_b32 s80, 120, s80
    s_cselect_b32 s81, 7, s81
    s_cmp_ge_u32 s78, 8
    s_cselect_b32 s80, 144, s80
    s_cselect_b32 s81, 4, s81
    s_cmp_ge_u32 s78, 12
    s_cselect_b32 s80, 168, s80
    s_cselect_b32 s81, 2, s81
    s_cmp_ge_u32 s78, 14
    s_cselect_b32 s80, 196, s80
    s_cselect_b32 s81, 0, s81
    s_mul_i32 s78, s78, s81
    s_add_u32 s80, s80, s78
    s_cmp_eq_u32 s81, 0
    s_cbranch_scc1 L_cb_done
L_cb_put:
    s_mul_i32 s73, s80, 52429
    s_lshr_b32 s73, s73, 18
    s_mul_i32 s71, s73, 5
    s_sub_u32 s71, s80, s71
    s_add_u32 s71, s71, s72
    s_add_u32 s73, s73, 232
    s_add_u32 s74, s80, 3800
    s_lshr_b32 s75, s74, 4
    s_cmp_lt_u32 s80, 40
    s_cselect_b32 s73, s73, s75
    s_cselect_b32 s71, s71, s74
    s_and_b32 s74, s73, 15
    s_xor_b32 s71, s71, s74
    s_and_b32 s75, s73, 1
    s_lshl_b32 s74, s75, 0
    s_and_b32 s75, s73, 2
    s_lshl_b32 s75, s75, 2
    s_or_b32 s74, s74, s75
    s_and_b32 s75, s73, 4
    s_lshl_b32 s75, s75, 4
    s_or_b32 s74, s74, s75
    s_and_b32 s75, s73, 56
    s_lshl_b32 s75, s75, 5
    s_or_b32 s74, s74, s75
    s_and_b32 s75, s73, 192
    s_lshl_b32 s75, s75, 6
    s_or_b32 s74, s74, s75
    s_and_b32 s75, s71, 3
    s_lshl_b32 s73, s75, 1
    s_and_b32 s75, s71, 12
    s_lshl_b32 s75, s75, 2
    s_or_b32 s73, s73, s75
    s_or_b32 s74, s74, s73
    s_and_b32 s82, s79, 31
    s_lshl_b32 s82, s82, 2
    s_add_u32 s79, s79, 1
    s_lshl_b32 s83, s79, 16
    s_or_b32 s83, s83, s74
    v_mov_b32 v1, s82
    v_mov_b32 v2, s83
    ds_write_b32 v1, v2 offset:640
    s_add_u32 s80, s80, 1
    s_sub_u32 s81, s81, 1
    s_cmp_lg_u32 s81, 0
    s_cbranch_scc1 L_cb_put
L_cb_done:
    s_mov_b32 s76, s79
    s_add_u32 s77, s76, 4
L_cl_0:
    ds_read_b32 v1, v17 offset:0
    s_waitcnt lgkmcnt(0)
    v_readfirstlane_b32 s78, v1
    s_add_u32 s78, s78, 16
    s_ashr_i32 s78, s78, 1
    s_cmp_le_i32 s76, s78
    s_cbranch_scc1 L_cl_0_go
    s_sleep 2
    s_sub_u32 s3, s3, 1
    s_cbranch_scc0 L_cl_0
    s_endpgm
L_cl_0_go:
    global_atomic_add v20, v4, v5, s[26:27] sc0
    s_add_u32 s76, s76, 1
    s_cmp_lt_u32 s76, s77
    s_cbranch_scc1 L_cl_1
    s_waitcnt vmcnt(3)
    v_readfirstlane_b32 s80, v21
    s_cmp_ge_u32 s80, 100
    s_cbranch_scc1 L_cl_end
    s_add_u32 s80, s80, 196
    s_mul_i32 s73, s80, 52429
    s_lshr_b32 s73, s73, 18
    s_mul_i32 s71, s73, 5
    s_sub_u32 s71, s80, s71
    s_add_u32 s71, s71, s72
    s_add_u32 s73, s73, 232
    s_add_u32 s74, s80, 3800
    s_lshr_b32 s75, s74, 4
    s_cmp_lt_u32 s80, 40
    s_cselect_b32 s73, s73, s75
    s_cselect_b32 s71, s71, s74
    s_and_b32 s74, s73, 15
    s_xor_b32 s71, s71, s74
    s_and_b32 s75, s73, 1
    s_lshl_b32 s74, s75, 0
    s_and_b32 s75, s73, 2
    s_lshl_b32 s75, s75, 2
    s_or_b32 s74, s74, s75
    s_and_b32 s75, s73, 4
    s_lshl_b32 s75, s75, 4
    s_or_b32 s74, s74, s75
    s_and_b32 s75, s73, 56
    s_lshl_b32 s75, s75, 5
    s_or_b32 s74, s74, s75
    s_and_b32 s75, s73, 192
    s_lshl_b32 s75, s75, 6
    s_or_b32 s74, s74, s75
    s_and_b32 s75, s71, 3
    s_lshl_b32 s73, s75, 1
    s_and_b32 s75, s71, 12
    s_lshl_b32 s75, s75, 2
    s_or_b32 s73, s73, s75
    s_or_b32 s74, s74, s73
    s_and_b32 s82, s79, 31
    s_lshl_b32 s82, s82, 2
    s_add_u32 s79, s79, 1
    s_lshl_b32 s83, s79, 16
    s_or_b32 s83, s83, s74
    v_mov_b32 v1, s82
    v_mov_b32 v2, s83
    ds_write_b32 v1, v2 offset:640
L_cl_1:
    ds_read_b32 v1, v17 offset:0
    s_waitcnt lgkmcnt(0)
    v_readfirstlane_b32 s78, v1
    s_add_u32 s78, s78, 16
    s_ashr_i32 s78, s78, 1
    s_cmp_le_i32 s76, s78
    s_cbranch_scc1 L_cl_1_go
    s_sleep 2
    s_sub_u32 s3, s3, 1
    s_cbranch_scc0 L_cl_1
    s_endpgm
L_cl_1_go:
    global_atomic_add v21, v4, v5, s[26:27] sc0
    s_add_u32 s76, s76, 1
    s_cmp_lt_u32 s76, s77
    s_cbranch_scc1 L_cl_2
    s_waitcnt vmcnt(3)
    v_readfirstlane_b32 s80, v22
    s_cmp_ge_u32 s80, 100
    s_cbranch_scc1 L_cl_end
    s_add_u32 s80, s80, 196
    s_mul_i32 s73, s80, 52429
    s_lshr_b32 s73, s73, 18
    s_mul_i32 s71, s73, 5
    s_sub_u32 s71, s80, s71
    s_add_u32 s71, s71, s72
    s_add_u32 s73, s73, 232
    s_add_u32 s74, s80, 3800
    s_lshr_b32 s75, s74, 4
    s_cmp_lt_u32 s80, 40
    s_cselect_b32 s73, s73, s75
    s_cselect_b32 s71, s71, s74
    s_and_b32 s74, s73, 15
    s_xor_b32 s71, s71, s74
    s_and_b32 s75, s73, 1
    s_lshl_b32 s74, s75, 0
    s_and_b32 s75, s73, 2
    s_lshl_b32 s75, s75, 2
    s_or_b32 s74, s74, s75
    s_and_b32 s75, s73, 4
    s_lshl_b32 s75, s75, 4
    s_or_b32 s74, s74, s75
    s_and_b32 s75, s73, 56
    s_lshl_b32 s75, s75, 5
    s_or_b32 s74, s74, s75
    s_and_b32 s75, s73, 192
    s_lshl_b32 s75, s75, 6
    s_or_b32 s74, s74, s75
    s_and_b32 s75, s71, 3
    s_lshl_b32 s73, s75, 1
    s_and_b32 s75, s71, 12
    s_lshl_b32 s75, s75, 2
    s_or_b32 s73, s73, s75
    s_or_b32 s74, s74, s73
    s_and_b32 s82, s79, 31
    s_lshl_b32 s82, s82, 2
    s_add_u32 s79, s79, 1
    s_lshl_b32 s83, s79, 16
    s_or_b32 s83, s83, s74
    v_mov_b32 v1, s82
    v_mov_b32 v2, s83
    ds_write_b32 v1, v2 offset:640
L_cl_2:
    ds_read_b32 v1, v17 offset:0
    s_waitcnt lgkmcnt(0)
    v_readfirstlane_b32 s78, v1
    s_add_u32 s78, s78, 16
    s_ashr_i32 s78, s78, 1
    s_cmp_le_i32 s76, s78
    s_cbranch_scc1 L_cl_2_go
    s_sleep 2
    s_sub_u32 s3, s3, 1
    s_cbranch_scc0 L_cl_2
    s_endpgm
L_cl_2_go:
    global_atomic_add v22, v4, v5, s[26:27] sc0
    s_add_u32 s76, s76, 1
    s_cmp_lt_u32 s76, s77
    s_cbranch_scc1 L_cl_3
    s_waitcnt vmcnt(3)
    v_readfirstlane_b32 s80, v23
    s_cmp_ge_u32 s80, 100
    s_cbranch_scc1 L_cl_end
    s_add_u32 s80, s80, 196
    s_mul_i32 s73, s80, 52429
    s_lshr_b32 s73, s73, 18
    s_mul_i32 s71, s73, 5
    s_sub_u32 s71, s80, s71
    s_add_u32 s71, s71, s72
    s_add_u32 s73, s73, 232
    s_add_u32 s74, s80, 3800
    s_lshr_b32 s75, s74, 4
    s_cmp_lt_u32 s80, 40
    s_cselect_b32 s73, s73, s75
    s_cselect_b32 s71, s71, s74
    s_and_b32 s74, s73, 15
    s_xor_b32 s71, s71, s74
    s_and_b32 s75, s73, 1
    s_lshl_b32 s74, s75, 0
    s_and_b32 s75, s73, 2
    s_lshl_b32 s75, s75, 2
    s_or_b32 s74, s74, s75
    s_and_b32 s75, s73, 4
    s_lshl_b32 s75, s75, 4
    s_or_b32 s74, s74, s75
    s_and_b32 s75, s73, 56
    s_lshl_b32 s75, s75, 5
    s_or_b32 s74, s74, s75
    s_and_b32 s75, s73, 192
    s_lshl_b32 s75, s75, 6
    s_or_b32 s74, s74, s75
    s_and_b32 s75, s71, 3
    s_lshl_b32 s73, s75, 1
    s_and_b32 s75, s71, 12
    s_lshl_b32 s75, s75, 2
    s_or_b32 s73, s73, s75
    s_or_b32 s74, s74, s73
    s_and_b32 s82, s79, 31
    s_lshl_b32 s82, s82, 2
    s_add_u32 s79, s79, 1
    s_lshl_b32 s83, s79, 16
    s_or_b32 s83, s83, s74
    v_mov_b32 v1, s82
    v_mov_b32 v2, s83
    ds_write_b32 v1, v2 offset:640
L_cl_3:
    ds_read_b32 v1, v17 offset:0
    s_waitcnt lgkmcnt(0)
    v_readfirstlane_b32 s78, v1
    s_add_u32 s78, s78, 16
    s_ashr_i32 s78, s78, 1
    s_cmp_le_i32 s76, s78
    s_cbranch_scc1 L_cl_3_go
    s_sleep 2
    s_sub_u32 s3, s3, 1
    s_cbranch_scc0 L_cl_3
    s_endpgm
L_cl_3_go:
    global_atomic_add v23, v4, v5, s[26:27] sc0
    s_add_u32 s76, s76, 1
    s_cmp_lt_u32 s76, s77
    s_cbranch_scc1 L_cl_0
    s_waitcnt vmcnt(3)
    v_readfirstlane_b32 s80, v20
    s_cmp_ge_u32 s80, 100
    s_cbranch_scc1 L_cl_end
    s_add_u32 s80, s80, 196
    s_mul_i32 s73, s80, 52429
    s_lshr_b32 s73, s73, 18
    s_mul_i32 s71, s73, 5
    s_sub_u32 s71, s80, s71
    s_add_u32 s71, s71, s72
    s_add_u32 s73, s73, 232
    s_add_u32 s74, s80, 3800
    s_lshr_b32 s75, s74, 4
    s_cmp_lt_u32 s80, 40
    s_cselect_b32 s73, s73, s75
    s_cselect_b32 s71, s71, s74
    s_and_b32 s74, s73, 15
    s_xor_b32 s71, s71, s74
    s_and_b32 s75, s73, 1
    s_lshl_b32 s74, s75, 0
    s_and_b32 s75, s73, 2
    s_lshl_b32 s75, s75, 2
    s_or_b32 s74, s74, s75
    s_and_b32 s75, s73, 4
    s_lshl_b32 s75, s75, 4
    s_or_b32 s74, s74, s75
    s_and_b32 s75, s73, 56
    s_lshl_b32 s75, s75, 5
    s_or_b32 s74, s74, s75
    s_and_b32 s75, s73, 192
    s_lshl_b32 s75, s75, 6
    s_or_b32 s74, s74, s75
    s_and_b32 s75, s71, 3
    s_lshl_b32 s73, s75, 1
    s_and_b32 s75, s71, 12
    s_lshl_b32 s75, s75, 2
    s_or_b32 s73, s73, s75
    s_or_b32 s74, s74, s73
    s_and_b32 s82, s79, 31
    s_lshl_b32 s82, s82, 2
    s_add_u32 s79, s79, 1
    s_lshl_b32 s83, s79, 16
    s_or_b32 s83, s83, s74
    v_mov_b32 v1, s82
    v_mov_b32 v2, s83
    ds_write_b32 v1, v2 offset:640
    s_branch L_cl_0
L_cl_end:
    s_and_b32 s82, s79, 31
    s_lshl_b32 s82, s82, 2
    s_add_u32 s79, s79, 1
    s_lshl_b32 s83, s79, 16
    s_or_b32 s83, s83, 0xffff
    v_mov_b32 v1, s82
    v_mov_b32 v2, s83
    ds_write_b32 v1, v2 offset:640
    s_mov_b64 exec, -1
    s_cmp_lg_u32 s30, 10
    s_cbranch_scc1 L_e_done
    s_cmp_gt_u32 s29, 8
    s_cbranch_scc1 L_e_done
    s_mov_b64 s[68:69], s[22:23]
    s_mov_b32 s70, 1152
    s_mov_b32 s71, 0x20000
    v_lshrrev_b32 v4, 5, v0
    v_and_b32 v5, 3, v0
    v_lshl_add_u32 v4, v4, 2, v5
    v_bfe_u32 v5, v0, 2, 3
    v_lshl_add_u32 v4, v4, 3, v5
    v_lshlrev_b32 v2, 1, v4
    s_lshl_b32 s79, s29, 7
    buffer_load_ushort v3, v2, s[44:47], s79 offen
    v_lshlrev_b32 v4, 2, v0
    s_lshl_b32 s82, s29, 12
    s_mul_i32 s81, s29, 18432
    s_add_u32 s81, s81, 524288
L_f_ffn:
    s_mov_b32 s80, s81
    v_mov_b32 v22, 0
    buffer_load_dword v152, v4, s[40:43], s80 offen offset:0 sc1
    buffer_load_dword v153, v4, s[40:43], s80 offen offset:256 sc1
    buffer_load_dword v154, v4, s[40:43], s80 offen offset:512 sc1
    buffer_load_dword v155, v4, s[40:43], s80 offen offset:768 sc1
    buffer_load_dword v156, v4, s[40:43], s80 offen offset:1024 sc1
    buffer_load_dword v157, v4, s[40:43], s80 offen offset:1280 sc1
    buffer_load_dword v158, v4, s[40:43], s80 offen offset:1536 sc1
    buffer_load_dword v159, v4, s[40:43], s80 offen offset:1792 sc1
    buffer_load_dword v160, v4, s[40:43], s80 offen offset:2048 sc1
    buffer_load_dword v161, v4, s[40:43], s80 offen offset:2304 sc1
    buffer_load_dword v162, v4, s[40:43], s80 offen offset:2560 sc1
    buffer_load_dword v163, v4, s[40:43], s80 offen offset:2816 sc1
    buffer_load_dword v164, v4, s[40:43], s80 offen offset:3072 sc1
    buffer_load_dword v165, v4, s[40:43], s80 offen offset:3328 sc1
    buffer_load_dword v166, v4, s[40:43], s80 offen offset:3584 sc1
    buffer_load_dword v167, v4, s[40:43], s80 offen offset:3840 sc1
    s_add_u32 s80, s80, 0x1000
    buffer_load_dword v168, v4, s[40:43], s80 offen offset:0 sc1
    buffer_load_dword v169, v4, s[40:43], s80 offen offset:256 sc1
    buffer_load_dword v170, v4, s[40:43], s80 offen offset:512 sc1
    buffer_load_dword v171, v4, s[40:43], s80 offen offset:768 sc1
    buffer_load_dword v172, v4, s[40:43], s80 offen offset:1024 sc1
    buffer_load_dword v173, v4, s[40:43], s80 offen offset:1280 sc1
    buffer_load_dword v174, v4, s[40:43], s80 offen offset:1536 sc1
    buffer_load_dword v175, v4, s[40:43], s80 offen offset:1792 sc1
    buffer_load_dword v176, v4, s[40:43], s80 offen offset:2048 sc1
    buffer_load_dword v177, v4, s[40:43], s80 offen offset:2304 sc1
    buffer_load_dword v178, v4, s[40:43], s80 offen offset:2560 sc1
    buffer_load_dword v179, v4, s[40:43], s80 offen offset:2816 sc1
    buffer_load_dword v180, v4, s[40:43], s80 offen offset:3072 sc1
    buffer_load_dword v181, v4, s[40:43], s80 offen offset:3328 sc1
    buffer_load_dword v182, v4, s[40:43], s80 offen offset:3584 sc1
    buffer_load_dword v183, v4, s[40:43], s80 offen offset:3840 sc1
    s_add_u32 s80, s80, 0x1000
    buffer_load_dword v184, v4, s[40:43], s80 offen offset:0 sc1
    buffer_load_dword v185, v4, s[40:43], s80 offen offset:256 sc1
    buffer_load_dword v186, v4, s[40:43], s80 offen offset:512 sc1
    buffer_load_dword v187, v4, s[40:43], s80 offen offset:768 sc1
    buffer_load_dword v188, v4, s[40:43], s80 offen offset:1024 sc1
    buffer_load_dword v189, v4, s[40:43], s80 offen offset:1280 sc1
    buffer_load_dword v190, v4, s[40:43], s80 offen offset:1536 sc1
    buffer_load_dword v191, v4, s[40:43], s80 offen offset:1792 sc1
    buffer_load_dword v192, v4, s[40:43], s80 offen offset:2048 sc1
    buffer_load_dword v193, v4, s[40:43], s80 offen offset:2304 sc1
    buffer_load_dword v194, v4, s[40:43], s80 offen offset:2560 sc1
    buffer_load_dword v195, v4, s[40:43], s80 offen offset:2816 sc1
    buffer_load_dword v196, v4, s[40:43], s80 offen offset:3072 sc1
    buffer_load_dword v197, v4, s[40:43], s80 offen offset:3328 sc1
    buffer_load_dword v198, v4, s[40:43], s80 offen offset:3584 sc1
    buffer_load_dword v199, v4, s[40:43], s80 offen offset:3840 sc1
    s_add_u32 s80, s80, 0x1000
    s_waitcnt vmcnt(46)
    buffer_load_dword v200, v4, s[40:43], s80 offen offset:0 sc1
    buffer_load_dword v201, v4, s[40:43], s80 offen offset:256 sc1
    v_bitop3_b32 v1, v152, v153, v107 bitop3:0x7e
    v_add_f32 v22, v22, v152
    v_add_f32 v22, v22, v153
    s_waitcnt vmcnt(46)
    buffer_load_dword v202, v4, s[40:43], s80 offen offset:512 sc1
    buffer_load_dword v203, v4, s[40:43], s80 offen offset:768 sc1
    v_bitop3_b32 v1, v1, v154, v107 bitop3:0xf6
    v_bitop3_b32 v1, v1, v155, v107 bitop3:0xf6
    v_add_f32 v22, v22, v154
    v_add_f32 v22, v22, v155
    s_waitcnt vmcnt(46)
    buffer_load_dword v204, v4, s[40:43], s80 offen offset:1024 sc1
    buffer_load_dword v205, v4, s[40:43], s80 offen offset:1280 sc1
    v_bitop3_b32 v1, v1, v156, v107 bitop3:0xf6
    v_bitop3_b32 v1, v1, v157, v107 bitop3:0xf6
    v_add_f32 v22, v22, v156
    v_add_f32 v22, v22, v157
    s_waitcnt vmcnt(46)
    buffer_load_dword v206, v4, s[40:43], s80 offen offset:1536 sc1
    buffer_load_dword v207, v4, s[40:43], s80 offen offset:1792 sc1
    v_bitop3_b32 v1, v1, v158, v107 bitop3:0xf6
    v_bitop3_b32 v1, v1, v159, v107 bitop3:0xf6
    v_add_f32 v22, v22, v158
    v_add_f32 v22, v22, v159
    s_waitcnt vmcnt(46)
    buffer_load_dword v208, v4, s[40:43], s80 offen offset:2048 sc1
    buffer_load_dword v209, v4, s[40:43], s80 offen offset:2304 sc1
    v_bitop3_b32 v1, v1, v160, v107 bitop3:0xf6
    v_bitop3_b32 v1, v1, v161, v107 bitop3:0xf6
    v_add_f32 v22, v22, v160
    v_add_f32 v22, v22, v161
    s_waitcnt vmcnt(46)
    buffer_load_dword v210, v4, s[40:43], s80 offen offset:2560 sc1
    buffer_load_dword v211, v4, s[40:43], s80 offen offset:2816 sc1
    v_bitop3_b32 v1, v1, v162, v107 bitop3:0xf6
    v_bitop3_b32 v1, v1, v163, v107 bitop3:0xf6
    v_add_f32 v22, v22, v162
    v_add_f32 v22, v22, v163
    s_waitcnt vmcnt(46)
    buffer_load_dword v212, v4, s[40:43], s80 offen offset:3072 sc1
    buffer_load_dword v213, v4, s[40:43], s80 offen offset:3328 sc1
    v_bitop3_b32 v1, v1, v164, v107 bitop3:0xf6
    v_bitop3_b32 v1, v1, v165, v107 bitop3:0xf6
    v_add_f32 v22, v22, v164
    v_add_f32 v22, v22, v165
    s_waitcnt vmcnt(46)
    buffer_load_dword v214, v4, s[40:43], s80 offen offset:3584 sc1
    buffer_load_dword v215, v4, s[40:43], s80 offen offset:3840 sc1
    s_add_u32 s80, s80, 0x1000
    v_bitop3_b32 v1, v1, v166, v107 bitop3:0xf6
    v_bitop3_b32 v1, v1, v167, v107 bitop3:0xf6
    v_add_f32 v22, v22, v166
    v_add_f32 v22, v22, v167
    s_waitcnt vmcnt(46)
    buffer_load_dword v216, v4, s[40:43], s80 offen offset:0 sc1
    buffer_load_dword v217, v4, s[40:43], s80 offen offset:256 sc1
    v_bitop3_b32 v1, v1, v168, v107 bitop3:0xf6
    v_bitop3_b32 v1, v1, v169, v107 bitop3:0xf6
    v_add_f32 v22, v22, v168
    v_add_f32 v22, v22, v169
    s_waitcnt vmcnt(46)
    buffer_load_dword v218, v4, s[40:43], s80 offen offset:512 sc1
    buffer_load_dword v219, v4, s[40:43], s80 offen offset:768 sc1
    v_bitop3_b32 v1, v1, v170, v107 bitop3:0xf6
    v_bitop3_b32 v1, v1, v171, v107 bitop3:0xf6
    v_add_f32 v22, v22, v170
    v_add_f32 v22, v22, v171
    s_waitcnt vmcnt(46)
    buffer_load_dword v220, v4, s[40:43], s80 offen offset:1024 sc1
    buffer_load_dword v221, v4, s[40:43], s80 offen offset:1280 sc1
    v_bitop3_b32 v1, v1, v172, v107 bitop3:0xf6
    v_bitop3_b32 v1, v1, v173, v107 bitop3:0xf6
    v_add_f32 v22, v22, v172
    v_add_f32 v22, v22, v173
    s_waitcnt vmcnt(46)
    buffer_load_dword v222, v4, s[40:43], s80 offen offset:1536 sc1
    buffer_load_dword v223, v4, s[40:43], s80 offen offset:1792 sc1
    v_bitop3_b32 v1, v1, v174, v107 bitop3:0xf6
    v_bitop3_b32 v1, v1, v175, v107 bitop3:0xf6
    v_add_f32 v22, v22, v174
    v_add_f32 v22, v22, v175
    s_waitcnt vmcnt(46)
    v_bitop3_b32 v1, v1, v176, v107 bitop3:0xf6
    v_bitop3_b32 v1, v1, v177, v107 bitop3:0xf6
    v_add_f32 v22, v22, v176
    v_add_f32 v22, v22, v177
    s_waitcnt vmcnt(44)
    v_bitop3_b32 v1, v1, v178, v107 bitop3:0xf6
    v_bitop3_b32 v1, v1, v179, v107 bitop3:0xf6
    v_add_f32 v22, v22, v178
    v_add_f32 v22, v22, v179
    s_waitcnt vmcnt(42)
    v_bitop3_b32 v1, v1, v180, v107 bitop3:0xf6
    v_bitop3_b32 v1, v1, v181, v107 bitop3:0xf6
    v_add_f32 v22, v22, v180
    v_add_f32 v22, v22, v181
    s_waitcnt vmcnt(40)
    v_bitop3_b32 v1, v1, v182, v107 bitop3:0xf6
    v_bitop3_b32 v1, v1, v183, v107 bitop3:0xf6
    v_add_f32 v22, v22, v182
    v_add_f32 v22, v22, v183
    s_waitcnt vmcnt(38)
    v_bitop3_b32 v1, v1, v184, v107 bitop3:0xf6
    v_bitop3_b32 v1, v1, v185, v107 bitop3:0xf6
    v_add_f32 v22, v22, v184
    v_add_f32 v22, v22, v185
    s_waitcnt vmcnt(36)
    v_bitop3_b32 v1, v1, v186, v107 bitop3:0xf6
    v_bitop3_b32 v1, v1, v187, v107 bitop3:0xf6
    v_add_f32 v22, v22, v186
    v_add_f32 v22, v22, v187
    s_waitcnt vmcnt(34)
    v_bitop3_b32 v1, v1, v188, v107 bitop3:0xf6
    v_bitop3_b32 v1, v1, v189, v107 bitop3:0xf6
    v_add_f32 v22, v22, v188
    v_add_f32 v22, v22, v189
    s_waitcnt vmcnt(32)
    v_bitop3_b32 v1, v1, v190, v107 bitop3:0xf6
    v_bitop3_b32 v1, v1, v191, v107 bitop3:0xf6
    v_add_f32 v22, v22, v190
    v_add_f32 v22, v22, v191
    s_waitcnt vmcnt(30)
    v_bitop3_b32 v1, v1, v192, v107 bitop3:0xf6
    v_bitop3_b32 v1, v1, v193, v107 bitop3:0xf6
    v_add_f32 v22, v22, v192
    v_add_f32 v22, v22, v193
    s_waitcnt vmcnt(28)
    v_bitop3_b32 v1, v1, v194, v107 bitop3:0xf6
    v_bitop3_b32 v1, v1, v195, v107 bitop3:0xf6
    v_add_f32 v22, v22, v194
    v_add_f32 v22, v22, v195
    s_waitcnt vmcnt(26)
    v_bitop3_b32 v1, v1, v196, v107 bitop3:0xf6
    v_bitop3_b32 v1, v1, v197, v107 bitop3:0xf6
    v_add_f32 v22, v22, v196
    v_add_f32 v22, v22, v197
    s_waitcnt vmcnt(24)
    v_bitop3_b32 v1, v1, v198, v107 bitop3:0xf6
    v_bitop3_b32 v1, v1, v199, v107 bitop3:0xf6
    v_add_f32 v22, v22, v198
    v_add_f32 v22, v22, v199
    s_waitcnt vmcnt(22)
    v_bitop3_b32 v1, v1, v200, v107 bitop3:0xf6
    v_bitop3_b32 v1, v1, v201, v107 bitop3:0xf6
    v_add_f32 v22, v22, v200
    v_add_f32 v22, v22, v201
    s_waitcnt vmcnt(20)
    v_bitop3_b32 v1, v1, v202, v107 bitop3:0xf6
    v_bitop3_b32 v1, v1, v203, v107 bitop3:0xf6
    v_add_f32 v22, v22, v202
    v_add_f32 v22, v22, v203
    s_waitcnt vmcnt(18)
    v_bitop3_b32 v1, v1, v204, v107 bitop3:0xf6
    v_bitop3_b32 v1, v1, v205, v107 bitop3:0xf6
    v_add_f32 v22, v22, v204
    v_add_f32 v22, v22, v205
    s_waitcnt vmcnt(16)
    v_bitop3_b32 v1, v1, v206, v107 bitop3:0xf6
    v_bitop3_b32 v1, v1, v207, v107 bitop3:0xf6
    v_add_f32 v22, v22, v206
    v_add_f32 v22, v22, v207
    s_waitcnt vmcnt(14)
    v_bitop3_b32 v1, v1, v208, v107 bitop3:0xf6
    v_bitop3_b32 v1, v1, v209, v107 bitop3:0xf6
    v_add_f32 v22, v22, v208
    v_add_f32 v22, v22, v209
    s_waitcnt vmcnt(12)
    v_bitop3_b32 v1, v1, v210, v107 bitop3:0xf6
    v_bitop3_b32 v1, v1, v211, v107 bitop3:0xf6
    v_add_f32 v22, v22, v210
    v_add_f32 v22, v22, v211
    s_waitcnt vmcnt(10)
    v_bitop3_b32 v1, v1, v212, v107 bitop3:0xf6
    v_bitop3_b32 v1, v1, v213, v107 bitop3:0xf6
    v_add_f32 v22, v22, v212
    v_add_f32 v22, v22, v213
    s_waitcnt vmcnt(8)
    v_bitop3_b32 v1, v1, v214, v107 bitop3:0xf6
    v_bitop3_b32 v1, v1, v215, v107 bitop3:0xf6
    v_add_f32 v22, v22, v214
    v_add_f32 v22, v22, v215
    s_waitcnt vmcnt(6)
    v_bitop3_b32 v1, v1, v216, v107 bitop3:0xf6
    v_bitop3_b32 v1, v1, v217, v107 bitop3:0xf6
    v_add_f32 v22, v22, v216
    v_add_f32 v22, v22, v217
    s_waitcnt vmcnt(4)
    v_bitop3_b32 v1, v1, v218, v107 bitop3:0xf6
    v_bitop3_b32 v1, v1, v219, v107 bitop3:0xf6
    v_add_f32 v22, v22, v218
    v_add_f32 v22, v22, v219
    s_waitcnt vmcnt(2)
    v_bitop3_b32 v1, v1, v220, v107 bitop3:0xf6
    v_bitop3_b32 v1, v1, v221, v107 bitop3:0xf6
    v_add_f32 v22, v22, v220
    v_add_f32 v22, v22, v221
    s_waitcnt vmcnt(0)
    v_bitop3_b32 v1, v1, v222, v107 bitop3:0xf6
    v_bitop3_b32 v1, v1, v223, v107 bitop3:0xf6
    v_add_f32 v22, v22, v222
    v_add_f32 v22, v22, v223
    v_and_b32 v1, 0xff, v1
    v_cmp_ne_u32 vcc, 0, v1
    s_cbranch_vccz L_f_ffn_ok
    s_sleep 16
    s_sub_u32 s3, s3, 1
    s_cbranch_scc0 L_f_ffn
    s_endpgm
L_f_ffn_ok:
    v_cvt_pk_bf16_f32 v22, 0, v22
    v_mul_f32 v5, 0xbfb8aa3b, v22
    v_exp_f32 v5, v5
    s_nop 0
    v_add_f32 v5, 1.0, v5
    v_rcp_f32 v5, v5
    s_nop 0
    v_mul_f32 v22, v22, v5
    v_cvt_pk_bf16_f32 v22, 0, v22
    v_lshlrev_b32 v3, 16, v3
L_f_wait:
    ds_read_b64 v[24:25], v17 offset:0
    s_waitcnt lgkmcnt(0)
    v_cmp_ge_i32 vcc, v24, v25
    s_cbranch_vccnz L_f_go
    s_sleep 4
    s_sub_u32 s3, s3, 1
    s_cbranch_scc0 L_f_wait
    s_endpgm
L_f_go:
    s_add_u32 s80, s82, 458752
    buffer_load_dword v152, v4, s[40:43], s80 offen offset:0 sc1
    buffer_load_dword v153, v4, s[40:43], s80 offen offset:256 sc1
    buffer_load_dword v154, v4, s[40:43], s80 offen offset:512 sc1
    buffer_load_dword v155, v4, s[40:43], s80 offen offset:768 sc1
    buffer_load_dword v156, v4, s[40:43], s80 offen offset:1024 sc1
    buffer_load_dword v157, v4, s[40:43], s80 offen offset:1280 sc1
    buffer_load_dword v158, v4, s[40:43], s80 offen offset:1536 sc1
    buffer_load_dword v159, v4, s[40:43], s80 offen offset:1792 sc1
    buffer_load_dword v160, v4, s[40:43], s80 offen offset:2048 sc1
    buffer_load_dword v161, v4, s[40:43], s80 offen offset:2304 sc1
    buffer_load_dword v162, v4, s[40:43], s80 offen offset:2560 sc1
    buffer_load_dword v163, v4, s[40:43], s80 offen offset:2816 sc1
    buffer_load_dword v164, v4, s[40:43], s80 offen offset:3072 sc1
    buffer_load_dword v165, v4, s[40:43], s80 offen offset:3328 sc1
    buffer_load_dword v166, v4, s[40:43], s80 offen offset:3584 sc1
    buffer_load_dword v167, v4, s[40:43], s80 offen offset:3840 sc1
L_f_att:
    buffer_load_dword v168, v4, s[40:43], s80 offen offset:0 sc1
    buffer_load_dword v169, v4, s[40:43], s80 offen offset:256 sc1
    buffer_load_dword v170, v4, s[40:43], s80 offen offset:512 sc1
    buffer_load_dword v171, v4, s[40:43], s80 offen offset:768 sc1
    buffer_load_dword v172, v4, s[40:43], s80 offen offset:1024 sc1
    buffer_load_dword v173, v4, s[40:43], s80 offen offset:1280 sc1
    buffer_load_dword v174, v4, s[40:43], s80 offen offset:1536 sc1
    buffer_load_dword v175, v4, s[40:43], s80 offen offset:1792 sc1
    buffer_load_dword v176, v4, s[40:43], s80 offen offset:2048 sc1
    buffer_load_dword v177, v4, s[40:43], s80 offen offset:2304 sc1
    buffer_load_dword v178, v4, s[40:43], s80 offen offset:2560 sc1
    buffer_load_dword v179, v4, s[40:43], s80 offen offset:2816 sc1
    buffer_load_dword v180, v4, s[40:43], s80 offen offset:3072 sc1
    buffer_load_dword v181, v4, s[40:43], s80 offen offset:3328 sc1
    buffer_load_dword v182, v4, s[40:43], s80 offen offset:3584 sc1
    buffer_load_dword v183, v4, s[40:43], s80 offen offset:3840 sc1
    s_waitcnt vmcnt(30)
    v_bitop3_b32 v1, v152, v153, v107 bitop3:0x7e
    v_add_f32 v23, v152, v153
    s_waitcnt vmcnt(28)
    v_bitop3_b32 v1, v1, v154, v107 bitop3:0xf6
    v_bitop3_b32 v1, v1, v155, v107 bitop3:0xf6
    v_add_f32 v23, v23, v154
    v_add_f32 v23, v23, v155
    s_waitcnt vmcnt(26)
    v_bitop3_b32 v1, v1, v156, v107 bitop3:0xf6
    v_bitop3_b32 v1, v1, v157, v107 bitop3:0xf6
    v_add_f32 v23, v23, v156
    v_add_f32 v23, v23, v157
    s_waitcnt vmcnt(24)
    v_bitop3_b32 v1, v1, v158, v107 bitop3:0xf6
    v_bitop3_b32 v1, v1, v159, v107 bitop3:0xf6
    v_add_f32 v23, v23, v158
    v_add_f32 v23, v23, v159
    s_waitcnt vmcnt(22)
    v_bitop3_b32 v1, v1, v160, v107 bitop3:0xf6
    v_bitop3_b32 v1, v1, v161, v107 bitop3:0xf6
    v_add_f32 v23, v23, v160
    v_add_f32 v23, v23, v161
    s_waitcnt vmcnt(20)
    v_bitop3_b32 v1, v1, v162, v107 bitop3:0xf6
    v_bitop3_b32 v1, v1, v163, v107 bitop3:0xf6
    v_add_f32 v23, v23, v162
    v_add_f32 v23, v23, v163
    s_waitcnt vmcnt(18)
    v_bitop3_b32 v1, v1, v164, v107 bitop3:0xf6
    v_bitop3_b32 v1, v1, v165, v107 bitop3:0xf6
    v_add_f32 v23, v23, v164
    v_add_f32 v23, v23, v165
    s_waitcnt vmcnt(16)
    v_bitop3_b32 v1, v1, v166, v107 bitop3:0xf6
    v_bitop3_b32 v1, v1, v167, v107 bitop3:0xf6
    v_add_f32 v23, v23, v166
    v_add_f32 v23, v23, v167
    v_and_b32 v1, 0xff, v1
    v_cmp_ne_u32 vcc, 0, v1
    s_cbranch_vccz L_f_att_ok
    buffer_load_dword v152, v4, s[40:43], s80 offen offset:0 sc1
    buffer_load_dword v153, v4, s[40:43], s80 offen offset:256 sc1
    buffer_load_dword v154, v4, s[40:43], s80 offen offset:512 sc1
    buffer_load_dword v155, v4, s[40:43], s80 offen offset:768 sc1
    buffer_load_dword v156, v4, s[40:43], s80 offen offset:1024 sc1
    buffer_load_dword v157, v4, s[40:43], s80 offen offset:1280 sc1
    buffer_load_dword v158, v4, s[40:43], s80 offen offset:1536 sc1
    buffer_load_dword v159, v4, s[40:43], s80 offen offset:1792 sc1
    buffer_load_dword v160, v4, s[40:43], s80 offen offset:2048 sc1
    buffer_load_dword v161, v4, s[40:43], s80 offen offset:2304 sc1
    buffer_load_dword v162, v4, s[40:43], s80 offen offset:2560 sc1
    buffer_load_dword v163, v4, s[40:43], s80 offen offset:2816 sc1
    buffer_load_dword v164, v4, s[40:43], s80 offen offset:3072 sc1
    buffer_load_dword v165, v4, s[40:43], s80 offen offset:3328 sc1
    buffer_load_dword v166, v4, s[40:43], s80 offen offset:3584 sc1
    buffer_load_dword v167, v4, s[40:43], s80 offen offset:3840 sc1
    s_waitcnt vmcnt(30)
    v_bitop3_b32 v1, v168, v169, v107 bitop3:0x7e
    v_add_f32 v23, v168, v169
    s_waitcnt vmcnt(28)
    v_bitop3_b32 v1, v1, v170, v107 bitop3:0xf6
    v_bitop3_b32 v1, v1, v171, v107 bitop3:0xf6
    v_add_f32 v23, v23, v170
    v_add_f32 v23, v23, v171
    s_waitcnt vmcnt(26)
    v_bitop3_b32 v1, v1, v172, v107 bitop3:0xf6
    v_bitop3_b32 v1, v1, v173, v107 bitop3:0xf6
    v_add_f32 v23, v23, v172
    v_add_f32 v23, v23, v173
    s_waitcnt vmcnt(24)
    v_bitop3_b32 v1, v1, v174, v107 bitop3:0xf6
    v_bitop3_b32 v1, v1, v175, v107 bitop3:0xf6
    v_add_f32 v23, v23, v174
    v_add_f32 v23, v23, v175
    s_waitcnt vmcnt(22)
    v_bitop3_b32 v1, v1, v176, v107 bitop3:0xf6
    v_bitop3_b32 v1, v1, v177, v107 bitop3:0xf6
    v_add_f32 v23, v23, v176
    v_add_f32 v23, v23, v177
    s_waitcnt vmcnt(20)
    v_bitop3_b32 v1, v1, v178, v107 bitop3:0xf6
    v_bitop3_b32 v1, v1, v179, v107 bitop3:0xf6
    v_add_f32 v23, v23, v178
    v_add_f32 v23, v23, v179
    s_waitcnt vmcnt(18)
    v_bitop3_b32 v1, v1, v180, v107 bitop3:0xf6
    v_bitop3_b32 v1, v1, v181, v107 bitop3:0xf6
    v_add_f32 v23, v23, v180
    v_add_f32 v23, v23, v181
    s_waitcnt vmcnt(16)
    v_bitop3_b32 v1, v1, v182, v107 bitop3:0xf6
    v_bitop3_b32 v1, v1, v183, v107 bitop3:0xf6
    v_add_f32 v23, v23, v182
    v_add_f32 v23, v23, v183
    v_and_b32 v1, 0xff, v1
    v_cmp_ne_u32 vcc, 0, v1
    s_cbranch_vccz L_f_att_ok
    s_sub_u32 s3, s3, 1
    s_cbranch_scc0 L_f_att
    s_endpgm
L_f_att_ok:
    v_cvt_pk_bf16_f32 v23, 0, v23
    v_mul_f32 v23, v23, v22
    v_cvt_pk_bf16_f32 v23, 0, v23
    v_add_f32 v23, v23, v3
    v_cvt_pk_bf16_f32 v23, v23, v23
    buffer_store_short v23, v2, s[68:71], s79 offen sc1
    s_cmp_lg_u32 s29, 0
    s_cbranch_scc1 L_e_done
    s_mov_b64 exec, 1
    v_mov_b32 v4, 507904
    global_store_dword v4, v107, s[26:27] sc1
    s_mov_b64 exec, -1
    s_branch L_e_done
L_cons_main:
    s_cmp_lg_u32 s28, 1
    s_cbranch_scc1 L_tpf2_done
    s_lshl_b32 s82, s29, 24
    s_add_u32 s83, s82, 0xfffffc
    s_mov_b32 s80, 5308412
    s_mov_b32 s81, 4718588
    s_load_dword s35, s[20:21], 0
    s_load_dword s35, s[20:21], s80
    s_load_dword s35, s[6:7], s83
    s_load_dword s35, s[8:9], s82
    s_load_dword s35, s[8:9], s83
    s_load_dword s35, s[12:13], 0
    s_load_dword s35, s[12:13], s81
L_tpf2_done:
    v_and_b32 v1, 15, v0
    v_lshrrev_b32 v4, 4, v0
    v_xor_b32 v5, v1, v4
    v_lshlrev_b32 v5, 4, v5
    v_lshl_add_u32 v12, v1, 8, v5
    v_xor_b32 v13, 64, v12
    v_xor_b32 v14, 128, v12
    v_xor_b32 v15, 192, v12
    v_lshlrev_b32 v5, 4, v1
    v_lshl_add_u32 v16, v4, 10, v5
    v_mov_b32 v18, 0xff800000
    v_mov_b32 v19, 0xff800000
    v_mov_b32 v20, 0
    v_mov_b32 v24, 0
    v_mov_b32 v25, 0
    v_mov_b32 v26, 0
    v_mov_b32 v27, 0
    s_lshl_b32 s82, s31, 2
    v_mov_b32 v21, s82
    v_lshrrev_b32 v2, 3, v0
    v_lshlrev_b32 v2, 3, v2
    s_lshl_b32 s82, s31, 6
    v_add_u32 v148, s82, v2
    v_bfe_u32 v5, v0, 3, 1
    v_lshlrev_b32 v5, 8, v5
    v_lshl_add_u32 v5, v4, 4, v5
    s_mov_b32 s72, 0x3db504f3
    s_mov_b32 s73, 0x3fb8aa3b
    s_mov_b32 s74, 0xffff0000
    s_mov_b32 s76, s31
    s_lshl_b32 s77, s31, 12
    s_add_u32 s77, s77, 19456
    s_mov_b32 s78, 0
    s_mov_b32 s60, s15
    s_mov_b32 s61, 0
    s_add_u32 s34, s31, 24
    s_cmp_lt_i32 s63, 0
    s_cselect_b32 s34, -1, s34
    s_mov_b64 s[52:53], s[12:13]
    s_mov_b32 s54, 4718592
    s_mov_b32 s55, 0x20000
    s_sub_u32 s82, s30, 1
    s_cmp_gt_u32 s82, 8
    s_cselect_b32 s54, 0, s54
    v_lshrrev_b32 v2, 5, v0
    v_lshlrev_b32 v2, 7, v2
    v_bfe_u32 v3, v0, 3, 2
    v_lshl_add_u32 v2, v3, 1, v2
    v_mul_u32_u24 v2, 0x480, v2
    v_and_b32 v3, 7, v0
    v_lshl_add_u32 v106, v3, 4, v2
    s_lshl_b32 s82, s82, 7
    s_lshl_b32 s83, s29, 3
    s_add_u32 s83, s83, s31
    s_mul_i32 s83, s83, 36864
    s_add_u32 s48, s82, s83
    s_add_u32 s49, s48, 9216
    s_add_u32 s50, s48, 18432
    s_add_u32 s51, s48, 27648
    s_add_u32 s82, s31, 1
    s_and_b32 s82, s82, 3
    s_lshl_b32 s83, s82, 9
    s_lshl_b32 s82, s82, 10
    v_lshl_add_u32 v140, v0, 3, s83
    v_lshl_add_u32 v141, v0, 4, s82
    s_add_u32 s82, s31, 2
    s_and_b32 s82, s82, 3
    s_lshl_b32 s83, s82, 9
    s_lshl_b32 s82, s82, 10
    v_lshl_add_u32 v142, v0, 3, s83
    v_lshl_add_u32 v143, v0, 4, s82
    s_add_u32 s82, s31, 3
    s_and_b32 s82, s82, 3
    s_lshl_b32 s83, s82, 9
    s_lshl_b32 s82, s82, 10
    v_lshl_add_u32 v144, v0, 3, s83
    v_lshl_add_u32 v145, v0, 4, s82
    v_lshrrev_b32 v2, 4, v0
    v_and_b32 v3, 15, v0
    v_lshlrev_b32 v3, 4, v3
    v_lshl_add_u32 v146, v2, 12, v3
    v_lshl_add_u32 v147, v2, 10, v3
    s_lshl_b32 s56, s29, 14
    s_add_u32 s56, s56, 131072
    s_lshl_b32 s83, s30, 8
    s_add_u32 s58, s56, s83
    s_lshl_b32 s83, s31, 12
    s_add_u32 s56, s56, s83
    s_lshl_b32 s57, s29, 12
    s_add_u32 s57, s57, 393216
    s_lshl_b32 s83, s30, 6
    s_add_u32 s59, s83, s57
    s_lshl_b32 s83, s31, 10
    s_add_u32 s57, s57, s83
    s_mov_b32 s70, -1
    s_brev_b32 s75, -2
L_qwait:
    ds_read_b32 v1, v17 offset:528
    s_waitcnt lgkmcnt(0)
    v_readfirstlane_b32 s79, v1
    s_cmp_lg_u32 s79, 0
    s_cbranch_scc1 L_qgo
    s_sleep 1
    s_sub_u32 s3, s3, 1
    s_cbranch_scc0 L_qwait
    s_endpgm
L_qgo:
    s_add_u32 s82, s100, 0x9e3779b9
    v_mov_b32 v107, s82
    s_mov_b32 s101, 0x07060500
    ds_read_b128 v[28:31], v5 offset:1024
    ds_read_b128 v[32:35], v5 offset:1088
    ds_read_b128 v[36:39], v5 offset:1152
    ds_read_b128 v[40:43], v5 offset:1216
    s_waitcnt lgkmcnt(0)
    v_mov_b32 v150, v23
    s_cmp_ge_i32 s63, 0
    s_cbranch_scc1 L_c_wd
L_k:
    s_cmp_lt_i32 s76, s78
    s_cbranch_scc1 L_k_go
L_k_poll:
    ds_read_b32 v22, v17 offset:0
    s_waitcnt lgkmcnt(0)
    v_readfirstlane_b32 s78, v22
    s_cmp_lt_i32 s76, s78
    s_cbranch_scc1 L_k_go
    s_sub_u32 s3, s3, 1
    s_cbranch_scc0 L_k_poll
    s_endpgm
L_k_go:
    v_add_u32 v100, s77, v12
    ds_read_b128 v[44:47], v100
    v_add_u32 v101, s77, v13
    ds_read_b128 v[48:51], v101
    v_add_u32 v102, s77, v14
    ds_read_b128 v[52:55], v102
    v_add_u32 v103, s77, v15
    ds_read_b128 v[56:59], v103
    s_add_u32 s77, s77, 16384
    s_sub_u32 s79, s77, 139264
    s_cmp_ge_u32 s77, 158720
    s_cselect_b32 s77, s79, s77
    s_add_u32 s76, s76, 1
    v_mov_b32 v22, s76
    s_add_u32 s76, s76, 3
    s_waitcnt lgkmcnt(3)
    v_mfma_f32_16x16x32_bf16 v[76:79], v[44:47], v[28:31], 0
    s_waitcnt lgkmcnt(2)
    v_mfma_f32_16x16x32_bf16 v[76:79], v[48:51], v[32:35], v[76:79]
    s_waitcnt lgkmcnt(1)
    v_mfma_f32_16x16x32_bf16 v[76:79], v[52:55], v[36:39], v[76:79]
    s_waitcnt lgkmcnt(0)
    v_mfma_f32_16x16x32_bf16 v[76:79], v[56:59], v[40:43], v[76:79]
    ds_write_b32 v21, v22 offset:512
    s_mov_b32 exec_lo, 0x01010101
    s_mov_b32 exec_hi, 0x01010101
    s_nop 4
    v_cvt_pk_bf16_f32 v76, 0, v76
    v_cvt_pk_bf16_f32 v77, 0, v77
    v_cvt_pk_bf16_f32 v78, 0, v78
    v_cvt_pk_bf16_f32 v79, 0, v79
    v_mul_f32 v76, s72, v76
    v_mul_f32 v77, s72, v77
    v_mul_f32 v78, s72, v78
    v_mul_f32 v79, s72, v79
    v_cvt_pk_bf16_f32 v22, v76, v77
    v_cvt_pk_bf16_f32 v23, v78, v79
    ds_write_b64 v148, v[22:23] offset:2560
    s_mov_b64 exec, -1
    v_add_u32 v148, 0x100, v148
    s_cmp_eq_u32 s76, s34
    s_cbranch_scc1 L_c_down
L_k_on:
    s_cmp_lt_u32 s76, s60
    s_cbranch_scc1 L_k
    s_cmp_lg_u32 s61, 0
    s_cbranch_scc1 L_k_end
L_k_nm:
    ds_read_b32 v22, v17 offset:556
    s_waitcnt lgkmcnt(0)
    v_readfirstlane_b32 s82, v22
    s_sub_u32 s82, s82, 1
    s_cbranch_scc0 L_k_nm_ok
    s_sub_u32 s3, s3, 1
    s_cbranch_scc0 L_k_nm
    s_endpgm
L_k_nm_ok:
    s_add_u32 s60, s60, s82
    s_lshl_b32 s61, s60, 1
    s_branch L_k_on
L_k_end:
    s_lshl_b32 s82, s60, 6
    v_subrev_u32 v148, s82, v148
L_v:
    s_cmp_lt_i32 s76, s78
    s_cbranch_scc1 L_v_go
L_v_poll:
    ds_read_b32 v22, v17 offset:0
    s_waitcnt lgkmcnt(0)
    v_readfirstlane_b32 s78, v22
    s_cmp_lt_i32 s76, s78
    s_cbranch_scc1 L_v_go
    s_sub_u32 s3, s3, 1
    s_cbranch_scc0 L_v_poll
    s_endpgm
L_v_go:
    ds_read_b64 v[22:23], v148 offset:2560
    v_add_u32 v104, s77, v16
    ds_read_b128 v[60:63], v104 offset:0
    ds_read_b128 v[64:67], v104 offset:256
    ds_read_b128 v[68:71], v104 offset:512
    ds_read_b128 v[72:75], v104 offset:768
    s_add_u32 s77, s77, 16384
    s_sub_u32 s79, s77, 139264
    s_cmp_ge_u32 s77, 158720
    s_cselect_b32 s77, s79, s77
    v_add_u32 v148, 0x100, v148
    s_add_u32 s76, s76, 1
    v_mov_b32 v100, s76
    s_add_u32 s76, s76, 3
    s_waitcnt lgkmcnt(4)
    v_lshlrev_b32 v76, 16, v22
    v_and_b32 v77, s74, v22
    v_lshlrev_b32 v78, 16, v23
    v_and_b32 v79, s74, v23
    v_max3_f32 v22, v76, v77, v78
    v_max_f32 v22, v22, v79
    v_cmp_gt_f32 vcc, v22, v18
    s_cbranch_vccnz L_v_rescale
L_v_cont:
    v_fma_f32 v80, v76, s73, -v19
    v_fma_f32 v81, v77, s73, -v19
    v_fma_f32 v82, v78, s73, -v19
    v_fma_f32 v83, v79, s73, -v19
    v_exp_f32 v80, v80
    v_exp_f32 v81, v81
    v_exp_f32 v82, v82
    v_exp_f32 v83, v83
    s_waitcnt lgkmcnt(0)
    ds_write_b32 v21, v100 offset:512
    v_cvt_pk_bf16_f32 v22, v80, v80
    v_and_b32 v84, v22, v8
    v_and_b32 v85, v22, v9
    v_and_b32 v86, v22, v10
    v_and_b32 v87, v22, v11
    v_add_f32 v20, v20, v80
    v_cvt_pk_bf16_f32 v22, v81, v81
    v_and_b32 v88, v22, v8
    v_and_b32 v89, v22, v9
    v_and_b32 v90, v22, v10
    v_and_b32 v91, v22, v11
    v_add_f32 v20, v20, v81
    v_mfma_f32_16x16x32_bf16 v[24:27], v[60:63], v[84:87], v[24:27]
    v_cvt_pk_bf16_f32 v22, v82, v82
    v_and_b32 v92, v22, v8
    v_and_b32 v93, v22, v9
    v_and_b32 v94, v22, v10
    v_and_b32 v95, v22, v11
    v_add_f32 v20, v20, v82
    v_mfma_f32_16x16x32_bf16 v[24:27], v[64:67], v[88:91], v[24:27]
    v_cvt_pk_bf16_f32 v22, v83, v83
    v_and_b32 v96, v22, v8
    v_and_b32 v97, v22, v9
    v_and_b32 v98, v22, v10
    v_and_b32 v99, v22, v11
    v_add_f32 v20, v20, v83
    v_mfma_f32_16x16x32_bf16 v[24:27], v[68:71], v[92:95], v[24:27]
    s_nop 0
    v_mfma_f32_16x16x32_bf16 v[24:27], v[72:75], v[96:99], v[24:27]
    s_cmp_lt_u32 s76, s61
    s_cbranch_scc1 L_v
    s_add_u32 s76, s76, s31
    s_lshl_b32 s82, s31, 12
    s_add_u32 s77, s77, s82
    s_sub_u32 s79, s77, 139264
    s_cmp_ge_u32 s77, 158720
    s_cselect_b32 s77, s79, s77
L_c_top:
    s_cmp_lt_i32 s76, s78
    s_cbranch_scc1 L_c_go
    s_cmp_ge_i32 s76, s75
    s_cbranch_scc1 L_c_exit
L_c_poll:
    ds_read_b64 v[22:23], v17 offset:0
    s_waitcnt lgkmcnt(0)
    v_readfirstlane_b32 s78, v22
    v_readfirstlane_b32 s75, v23
    s_add_u32 s70, s75, 6
    s_cmp_lt_i32 s76, s78
    s_cbranch_scc1 L_c_go
    s_cmp_ge_i32 s76, s75
    s_cbranch_scc1 L_c_exit
    s_sub_u32 s3, s3, 1
    s_cbranch_scc0 L_c_poll
    s_endpgm
L_c_vwait:
    ds_read_b64 v[22:23], v17 offset:0
    s_waitcnt lgkmcnt(0)
    v_readfirstlane_b32 s78, v22
    v_readfirstlane_b32 s75, v23
    s_add_u32 s70, s75, 6
    s_cmp_lt_i32 s82, s78
    s_cbranch_scc1 L_c_v
    s_sub_u32 s3, s3, 1
    s_cbranch_scc0 L_c_vwait
    s_endpgm
L_v_rescale:
    v_mov_b32 v23, v22
    s_nop 1
    v_permlane16_swap_b32 v23, v22
    v_max_f32 v22, v22, v23
    v_mov_b32 v23, v22
    s_nop 1
    v_permlane32_swap_b32 v23, v22
    v_max_f32 v22, v22, v23
    v_max_f32 v18, v18, v22
    v_mul_f32 v22, s73, v18
    v_sub_f32 v23, v19, v22
    v_exp_f32 v23, v23
    v_mov_b32 v19, v22
    v_mul_f32 v20, v20, v23
    v_mul_f32 v24, v24, v23
    v_mul_f32 v25, v25, v23
    v_mul_f32 v26, v26, v23
    v_mul_f32 v27, v27, v23
    s_branch L_v_cont
L_c_rescale:
    v_mov_b32 v23, v22
    s_nop 1
    v_permlane16_swap_b32 v23, v22
    v_max_f32 v22, v22, v23
    v_mov_b32 v23, v22
    s_nop 1
    v_permlane32_swap_b32 v23, v22
    v_max_f32 v22, v22, v23
    v_max_f32 v18, v18, v22
    v_mul_f32 v22, s73, v18
    v_sub_f32 v23, v19, v22
    v_exp_f32 v23, v23
    v_mov_b32 v19, v22
    v_mul_f32 v20, v20, v23
    v_mul_f32 v24, v24, v23
    v_mul_f32 v25, v25, v23
    v_mul_f32 v26, v26, v23
    v_mul_f32 v27, v27, v23
    s_branch L_c_cont
L_c_go:
    v_add_u32 v100, s77, v12
    ds_read_b128 v[44:47], v100
    v_add_u32 v101, s77, v13
    ds_read_b128 v[48:51], v101
    v_add_u32 v102, s77, v14
    ds_read_b128 v[52:55], v102
    v_add_u32 v103, s77, v15
    ds_read_b128 v[56:59], v103
    v_add_u32 v104, s77, v16
    s_add_u32 s77, s77, 32768
    s_sub_u32 s79, s77, 139264
    s_cmp_ge_u32 s77, 158720
    s_cselect_b32 s77, s79, s77
    s_waitcnt lgkmcnt(3)
    v_mfma_f32_16x16x32_bf16 v[76:79], v[44:47], v[28:31], 0
    s_waitcnt lgkmcnt(2)
    v_mfma_f32_16x16x32_bf16 v[76:79], v[48:51], v[32:35], v[76:79]
    s_waitcnt lgkmcnt(1)
    v_mfma_f32_16x16x32_bf16 v[76:79], v[52:55], v[36:39], v[76:79]
    s_waitcnt lgkmcnt(0)
    v_mfma_f32_16x16x32_bf16 v[76:79], v[56:59], v[40:43], v[76:79]
    s_add_u32 s82, s76, 1
    s_cmp_lt_i32 s82, s78
    s_cbranch_scc0 L_c_vwait
L_c_v:
    ds_read_b128 v[60:63], v104 offset:4096
    ds_read_b128 v[64:67], v104 offset:4352
    ds_read_b128 v[68:71], v104 offset:4608
    ds_read_b128 v[72:75], v104 offset:4864
    s_add_u32 s76, s76, 2
    v_mov_b32 v100, s76
    s_add_u32 s76, s76, 6
    v_cvt_pk_bf16_f32 v76, 0, v76
    v_cvt_pk_bf16_f32 v77, 0, v77
    v_cvt_pk_bf16_f32 v78, 0, v78
    v_cvt_pk_bf16_f32 v79, 0, v79
    v_mul_f32 v76, s72, v76
    v_mul_f32 v77, s72, v77
    v_mul_f32 v78, s72, v78
    v_mul_f32 v79, s72, v79
    v_cvt_pk_bf16_f32 v76, 0, v76
    v_cvt_pk_bf16_f32 v77, 0, v77
    v_cvt_pk_bf16_f32 v78, 0, v78
    v_cvt_pk_bf16_f32 v79, 0, v79
    v_max3_f32 v22, v76, v77, v78
    v_max_f32 v22, v22, v79
    v_cmp_gt_f32 vcc, v22, v18
    s_cbranch_vccnz L_c_rescale
L_c_cont:
    v_fma_f32 v80, v76, s73, -v19
    v_fma_f32 v81, v77, s73, -v19
    v_fma_f32 v82, v78, s73, -v19
    v_fma_f32 v83, v79, s73, -v19
    v_exp_f32 v80, v80
    v_exp_f32 v81, v81
    v_exp_f32 v82, v82
    v_exp_f32 v83, v83
    s_waitcnt lgkmcnt(0)
    ds_write_b32 v21, v100 offset:512
    s_cmp_lg_u32 s76, s70
    s_cbranch_scc1 L_c_pvb
    s_mov_b32 s61, 0
    ds_read_b32 v170, v17 offset:532
    ds_read_b64 v[164:165], v140 offset:6656
    ds_read_b64 v[166:167], v142 offset:6656
    ds_read_b64 v[168:169], v144 offset:6656
    ds_read_b128 v[152:155], v141 offset:2560
    ds_read_b128 v[156:159], v143 offset:2560
    ds_read_b128 v[160:163], v145 offset:2560
L_c_pvb:
    v_cvt_pk_bf16_f32 v22, v80, v80
    v_and_b32 v84, v22, v8
    v_and_b32 v85, v22, v9
    v_and_b32 v86, v22, v10
    v_and_b32 v87, v22, v11
    v_add_f32 v20, v20, v80
    v_cvt_pk_bf16_f32 v22, v81, v81
    v_and_b32 v88, v22, v8
    v_and_b32 v89, v22, v9
    v_and_b32 v90, v22, v10
    v_and_b32 v91, v22, v11
    v_add_f32 v20, v20, v81
    v_mfma_f32_16x16x32_bf16 v[24:27], v[60:63], v[84:87], v[24:27]
    v_cvt_pk_bf16_f32 v22, v82, v82
    v_and_b32 v92, v22, v8
    v_and_b32 v93, v22, v9
    v_and_b32 v94, v22, v10
    v_and_b32 v95, v22, v11
    v_add_f32 v20, v20, v82
    v_mfma_f32_16x16x32_bf16 v[24:27], v[64:67], v[88:91], v[24:27]
    v_cvt_pk_bf16_f32 v22, v83, v83
    v_and_b32 v96, v22, v8
    v_and_b32 v97, v22, v9
    v_and_b32 v98, v22, v10
    v_and_b32 v99, v22, v11
    v_add_f32 v20, v20, v83
    v_mfma_f32_16x16x32_bf16 v[24:27], v[68:71], v[92:95], v[24:27]
    s_nop 0
    v_mfma_f32_16x16x32_bf16 v[24:27], v[72:75], v[96:99], v[24:27]
    s_branch L_c_top
L_c_exit:
    v_mov_b32 v23, v20
    s_nop 1
    v_permlane16_swap_b32 v23, v20
    v_add_f32 v20, v20, v23
    v_mov_b32 v23, v20
    s_nop 1
    v_permlane32_swap_b32 v23, v20
    v_add_f32 v20, v20, v23
    s_cmp_eq_u32 s61, 0
    s_cbranch_scc1 L_e_dir
    s_lshr_b32 s82, s75, 1
    s_sub_u32 s82, s82, 1
    s_and_b32 s82, s82, 3
    s_cmp_eq_u32 s82, s31
    s_cbranch_scc1 L_e_re
    s_lshl_b32 s82, s31, 10
    v_lshl_add_u32 v4, v0, 4, s82
    ds_write_b128 v4, v[24:27] offset:2560
    s_lshl_b32 s82, s31, 9
    v_lshl_add_u32 v4, v0, 3, s82
    v_mov_b32 v22, v19
    v_mov_b32 v23, v20
    ds_write_b64 v4, v[22:23] offset:6656
    v_mov_b32 v1, 1
    s_mov_b64 exec, 1
    ds_add_u32 v17, v1 offset:532
    s_mov_b64 exec, -1
    buffer_load_dwordx4 v[108:111], v106, s[52:55], s48 offen offset:0 nt
    buffer_load_dwordx4 v[112:115], v106, s[52:55], s49 offen offset:0 nt
    buffer_load_dwordx4 v[116:119], v106, s[52:55], s50 offen offset:0 nt
    buffer_load_dwordx4 v[120:123], v106, s[52:55], s51 offen offset:0 nt
    buffer_load_dwordx4 v[124:127], v106, s[52:55], s48 offen offset:1152 nt
    buffer_load_dwordx4 v[128:131], v106, s[52:55], s49 offen offset:1152 nt
    buffer_load_dwordx4 v[132:135], v106, s[52:55], s50 offen offset:1152 nt
    buffer_load_dwordx4 v[136:139], v106, s[52:55], s51 offen offset:1152 nt
L_e_wait:
    ds_read_b32 v1, v17 offset:540
    s_waitcnt lgkmcnt(0)
    v_cmp_ne_u32 vcc, 0, v1
    s_cbranch_vccnz L_e_l1p
    s_sub_u32 s3, s3, 1
    s_cbranch_scc0 L_e_wait
    s_endpgm
L_e_re:
    ds_read_b32 v170, v17 offset:532
    ds_read_b64 v[164:165], v140 offset:6656
    ds_read_b64 v[166:167], v142 offset:6656
    ds_read_b64 v[168:169], v144 offset:6656
    ds_read_b128 v[152:155], v141 offset:2560
    ds_read_b128 v[156:159], v143 offset:2560
    ds_read_b128 v[160:163], v145 offset:2560
L_e_dir:
    s_waitcnt lgkmcnt(3)
    v_cmp_ne_u32 vcc, 3, v170
    v_max3_f32 v22, v164, v166, v168
    s_cbranch_vccz L_e_go
    s_sub_u32 s3, s3, 1
    s_cbranch_scc0 L_e_re
    s_endpgm
L_e_go:
    v_max_f32 v22, v22, v19
    v_sub_f32 v19, v19, v22
    v_sub_f32 v164, v164, v22
    v_sub_f32 v166, v166, v22
    v_sub_f32 v168, v168, v22
    v_exp_f32 v19, v19
    v_exp_f32 v164, v164
    v_exp_f32 v166, v166
    v_exp_f32 v168, v168
    v_mul_f32 v24, v19, v24
    v_mul_f32 v25, v19, v25
    v_mul_f32 v26, v19, v26
    v_mul_f32 v27, v19, v27
    s_waitcnt lgkmcnt(0)
    v_fmac_f32 v24, v164, v152
    v_fmac_f32 v25, v164, v153
    v_fmac_f32 v26, v164, v154
    v_fmac_f32 v27, v164, v155
    v_fmac_f32 v24, v166, v156
    v_fmac_f32 v25, v166, v157
    v_fmac_f32 v26, v166, v158
    v_fmac_f32 v27, v166, v159
    v_fmac_f32 v24, v168, v160
    v_fmac_f32 v25, v168, v161
    v_fmac_f32 v26, v168, v162
    v_fmac_f32 v27, v168, v163
    v_perm_b32 v24, v24, v107, s101
    v_perm_b32 v25, v25, v107, s101
    v_perm_b32 v26, v26, v107, s101
    v_perm_b32 v27, v27, v107, s101
    buffer_store_dwordx4 v[24:27], v146, s[40:43], s58 offen sc1
    v_mul_f32 v23, v19, v20
    v_fmac_f32 v23, v164, v165
    v_fmac_f32 v23, v166, v167
    v_fmac_f32 v23, v168, v169
    v_perm_b32 v44, v22, v107, s101
    v_perm_b32 v45, v23, v107, s101
    s_nop 0
    v_mov_b32_dpp v46, v44 row_ror:8 row_mask:0xf bank_mask:0xf
    v_mov_b32_dpp v47, v45 row_ror:8 row_mask:0xf bank_mask:0xf
    s_mov_b32 exec_lo, 0x000f000f
    s_mov_b32 exec_hi, 0x000f000f
    buffer_store_dwordx4 v[44:47], v147, s[40:43], s59 offen sc1
    s_mov_b64 exec, -1
    v_mov_b32 v1, 1
    ds_write_b32 v17, v1 offset:540
    buffer_load_dwordx4 v[108:111], v106, s[52:55], s48 offen offset:0 nt
    buffer_load_dwordx4 v[112:115], v106, s[52:55], s49 offen offset:0 nt
    buffer_load_dwordx4 v[116:119], v106, s[52:55], s50 offen offset:0 nt
    buffer_load_dwordx4 v[120:123], v106, s[52:55], s51 offen offset:0 nt
    buffer_load_dwordx4 v[124:127], v106, s[52:55], s48 offen offset:1152 nt
    buffer_load_dwordx4 v[128:131], v106, s[52:55], s49 offen offset:1152 nt
    buffer_load_dwordx4 v[132:135], v106, s[52:55], s50 offen offset:1152 nt
    buffer_load_dwordx4 v[136:139], v106, s[52:55], s51 offen offset:1152 nt
L_e_l1p:
    s_mov_b32 s76, s56
    s_mov_b32 s77, s57
    v_lshlrev_b32 v6, 2, v0
L_e_l1:
    s_waitcnt lgkmcnt(0)
    s_sub_u32 s78, s30, 1
    s_cmp_gt_u32 s78, 8
    s_cbranch_scc1 L_e_done
    v_and_b32 v4, 15, v0
    v_lshlrev_b32 v4, 6, v4
    v_lshrrev_b32 v5, 5, v0
    v_lshl_add_u32 v4, v5, 3, v4
L_l1_poll:
    buffer_load_dwordx2 v[184:185], v4, s[40:43], s77 offen sc1
    buffer_load_dword v152, v6, s[40:43], s76 offen offset:0 sc1
    buffer_load_dword v153, v6, s[40:43], s76 offen offset:256 sc1
    buffer_load_dword v154, v6, s[40:43], s76 offen offset:512 sc1
    buffer_load_dword v155, v6, s[40:43], s76 offen offset:768 sc1
    buffer_load_dword v156, v6, s[40:43], s76 offen offset:1024 sc1
    buffer_load_dword v157, v6, s[40:43], s76 offen offset:1280 sc1
    buffer_load_dword v158, v6, s[40:43], s76 offen offset:1536 sc1
    buffer_load_dword v159, v6, s[40:43], s76 offen offset:1792 sc1
    buffer_load_dword v160, v6, s[40:43], s76 offen offset:2048 sc1
    buffer_load_dword v161, v6, s[40:43], s76 offen offset:2304 sc1
    buffer_load_dword v162, v6, s[40:43], s76 offen offset:2560 sc1
    buffer_load_dword v163, v6, s[40:43], s76 offen offset:2816 sc1
    buffer_load_dword v164, v6, s[40:43], s76 offen offset:3072 sc1
    buffer_load_dword v165, v6, s[40:43], s76 offen offset:3328 sc1
    buffer_load_dword v166, v6, s[40:43], s76 offen offset:3584 sc1
    buffer_load_dword v167, v6, s[40:43], s76 offen offset:3840 sc1
    s_waitcnt vmcnt(16)
    v_mov_b32 v7, v184
    v_bitop3_b32 v1, v184, v185, v107 bitop3:0x7e
    v_and_b32 v2, 0xff, v1
    v_cmp_ne_u32 vcc, 0, v2
    s_cbranch_vccnz L_l1_again
    v_mov_b32 v76, 0
    v_max_f32_dpp v7, v7, v7 row_ror:8 row_mask:0xf bank_mask:0xf
    v_mov_b32 v77, 0
    s_nop 0
    v_max_f32_dpp v7, v7, v7 row_ror:4 row_mask:0xf bank_mask:0xf
    v_mov_b32 v78, 0
    s_nop 0
    v_max_f32_dpp v7, v7, v7 row_ror:2 row_mask:0xf bank_mask:0xf
    v_mov_b32 v79, 0
    s_nop 0
    v_max_f32_dpp v7, v7, v7 row_ror:1 row_mask:0xf bank_mask:0xf
    v_sub_f32 v22, v184, v7
    v_exp_f32 v22, v22
    s_nop 0
    v_mul_f32 v23, v22, v185
    s_waitcnt vmcnt(14)
    v_bitop3_b32 v1, v1, v152, v107 bitop3:0xf6
    v_bitop3_b32 v1, v1, v153, v107 bitop3:0xf6
    v_add_f32_dpp v23, v23, v23 row_ror:8 row_mask:0xf bank_mask:0xf
    v_fmac_f32_dpp v76, v22, v152 row_newbcast:0 row_mask:0xf bank_mask:0xf
    v_fmac_f32_dpp v77, v22, v153 row_newbcast:1 row_mask:0xf bank_mask:0xf
    s_waitcnt vmcnt(12)
    v_bitop3_b32 v1, v1, v154, v107 bitop3:0xf6
    v_bitop3_b32 v1, v1, v155, v107 bitop3:0xf6
    v_add_f32_dpp v23, v23, v23 row_ror:4 row_mask:0xf bank_mask:0xf
    v_fmac_f32_dpp v78, v22, v154 row_newbcast:2 row_mask:0xf bank_mask:0xf
    v_fmac_f32_dpp v79, v22, v155 row_newbcast:3 row_mask:0xf bank_mask:0xf
    s_waitcnt vmcnt(10)
    v_bitop3_b32 v1, v1, v156, v107 bitop3:0xf6
    v_bitop3_b32 v1, v1, v157, v107 bitop3:0xf6
    v_add_f32_dpp v23, v23, v23 row_ror:2 row_mask:0xf bank_mask:0xf
    v_fmac_f32_dpp v76, v22, v156 row_newbcast:4 row_mask:0xf bank_mask:0xf
    v_fmac_f32_dpp v77, v22, v157 row_newbcast:5 row_mask:0xf bank_mask:0xf
    s_waitcnt vmcnt(8)
    v_bitop3_b32 v1, v1, v158, v107 bitop3:0xf6
    v_bitop3_b32 v1, v1, v159, v107 bitop3:0xf6
    v_add_f32_dpp v23, v23, v23 row_ror:1 row_mask:0xf bank_mask:0xf
    v_fmac_f32_dpp v78, v22, v158 row_newbcast:6 row_mask:0xf bank_mask:0xf
    v_fmac_f32_dpp v79, v22, v159 row_newbcast:7 row_mask:0xf bank_mask:0xf
    s_waitcnt vmcnt(6)
    v_bitop3_b32 v1, v1, v160, v107 bitop3:0xf6
    v_bitop3_b32 v1, v1, v161, v107 bitop3:0xf6
    v_rcp_f32 v23, v23
    v_fmac_f32_dpp v76, v22, v160 row_newbcast:8 row_mask:0xf bank_mask:0xf
    v_fmac_f32_dpp v77, v22, v161 row_newbcast:9 row_mask:0xf bank_mask:0xf
    s_waitcnt vmcnt(4)
    v_bitop3_b32 v1, v1, v162, v107 bitop3:0xf6
    v_bitop3_b32 v1, v1, v163, v107 bitop3:0xf6
    v_fmac_f32_dpp v78, v22, v162 row_newbcast:10 row_mask:0xf bank_mask:0xf
    v_fmac_f32_dpp v79, v22, v163 row_newbcast:11 row_mask:0xf bank_mask:0xf
    s_waitcnt vmcnt(2)
    v_bitop3_b32 v1, v1, v164, v107 bitop3:0xf6
    v_bitop3_b32 v1, v1, v165, v107 bitop3:0xf6
    v_fmac_f32_dpp v76, v22, v164 row_newbcast:12 row_mask:0xf bank_mask:0xf
    v_fmac_f32_dpp v77, v22, v165 row_newbcast:13 row_mask:0xf bank_mask:0xf
    s_waitcnt vmcnt(0)
    v_bitop3_b32 v1, v1, v166, v107 bitop3:0xf6
    v_bitop3_b32 v1, v1, v167, v107 bitop3:0xf6
    v_fmac_f32_dpp v78, v22, v166 row_newbcast:14 row_mask:0xf bank_mask:0xf
    v_fmac_f32_dpp v79, v22, v167 row_newbcast:15 row_mask:0xf bank_mask:0xf
    v_and_b32 v1, 0xff, v1
    v_cmp_ne_u32 vcc, 0, v1
    v_add_f32 v2, v76, v77
    v_add_f32 v3, v78, v79
    s_cbranch_vccz L_l1_ok
L_l1_again:
    s_sub_u32 s3, s3, 1
    s_cbranch_scc0 L_l1_poll
    s_endpgm
L_l1_ok:
    v_add_f32 v1, v2, v3
    v_mul_f32 v1, v1, v23
    v_cvt_pk_bf16_f32 v1, v1, v1
    s_nop 1
    v_mov_b32_dpp v60, v1 row_newbcast:0 row_mask:0xf bank_mask:0x3
    v_mov_b32_dpp v61, v1 row_newbcast:1 row_mask:0xf bank_mask:0x3
    v_mov_b32_dpp v62, v1 row_newbcast:2 row_mask:0xf bank_mask:0x3
    v_mov_b32_dpp v63, v1 row_newbcast:3 row_mask:0xf bank_mask:0x3
    v_mov_b32_dpp v64, v1 row_newbcast:4 row_mask:0xf bank_mask:0x3
    v_mov_b32_dpp v65, v1 row_newbcast:5 row_mask:0xf bank_mask:0x3
    v_mov_b32_dpp v66, v1 row_newbcast:6 row_mask:0xf bank_mask:0x3
    v_mov_b32_dpp v67, v1 row_newbcast:7 row_mask:0xf bank_mask:0x3
    v_mov_b32_dpp v60, v1 row_newbcast:8 row_mask:0xf bank_mask:0xc
    v_mov_b32_dpp v61, v1 row_newbcast:9 row_mask:0xf bank_mask:0xc
    v_mov_b32_dpp v62, v1 row_newbcast:10 row_mask:0xf bank_mask:0xc
    v_mov_b32_dpp v63, v1 row_newbcast:11 row_mask:0xf bank_mask:0xc
    v_mov_b32_dpp v64, v1 row_newbcast:12 row_mask:0xf bank_mask:0xc
    v_mov_b32_dpp v65, v1 row_newbcast:13 row_mask:0xf bank_mask:0xc
    v_mov_b32_dpp v66, v1 row_newbcast:14 row_mask:0xf bank_mask:0xc
    v_mov_b32_dpp v67, v1 row_newbcast:15 row_mask:0xf bank_mask:0xc
    v_and_b32 v84, v60, v8
    v_and_b32 v85, v60, v9
    v_and_b32 v86, v60, v10
    v_and_b32 v87, v60, v11
    v_and_b32 v88, v61, v8
    v_and_b32 v89, v61, v9
    v_and_b32 v90, v61, v10
    v_and_b32 v91, v61, v11
    v_mfma_f32_16x16x32_bf16 v[76:79], v[108:111], v[84:87], 0
    v_and_b32 v92, v62, v8
    v_and_b32 v93, v62, v9
    v_and_b32 v94, v62, v10
    v_and_b32 v95, v62, v11
    v_mfma_f32_16x16x32_bf16 v[76:79], v[112:115], v[88:91], v[76:79]
    v_and_b32 v96, v63, v8
    v_and_b32 v97, v63, v9
    v_and_b32 v98, v63, v10
    v_and_b32 v99, v63, v11
    v_mfma_f32_16x16x32_bf16 v[76:79], v[116:119], v[92:95], v[76:79]
    v_and_b32 v84, v64, v8
    v_and_b32 v85, v64, v9
    v_and_b32 v86, v64, v10
    v_and_b32 v87, v64, v11
    v_mfma_f32_16x16x32_bf16 v[76:79], v[120:123], v[96:99], v[76:79]
    v_and_b32 v88, v65, v8
    v_and_b32 v89, v65, v9
    v_and_b32 v90, v65, v10
    v_and_b32 v91, v65, v11
    v_mfma_f32_16x16x32_bf16 v[76:79], v[124:127], v[84:87], v[76:79]
    v_and_b32 v92, v66, v8
    v_and_b32 v93, v66, v9
    v_and_b32 v94, v66, v10
    v_and_b32 v95, v66, v11
    v_mfma_f32_16x16x32_bf16 v[76:79], v[128:131], v[88:91], v[76:79]
    v_and_b32 v96, v67, v8
    v_and_b32 v97, v67, v9
    v_and_b32 v98, v67, v10
    v_and_b32 v99, v67, v11
    v_mfma_f32_16x16x32_bf16 v[76:79], v[132:135], v[92:95], v[76:79]
    s_nop 0
    v_mfma_f32_16x16x32_bf16 v[76:79], v[136:139], v[96:99], v[76:79]
    s_lshl_b32 s82, s31, 9
    v_lshrrev_b32 v4, 5, v0
    v_lshl_add_u32 v4, v4, 8, v105
    v_add_u32 v4, s82, v4
    v_mov_b32 v1, 1
    s_mov_b32 exec_lo, 0x00ff00ff
    s_mov_b32 exec_hi, 0xff00ff00
    s_lshl_b32 s82, s78, 12
    s_lshl_b32 s83, s29, 8
    s_add_u32 s82, s82, s83
    s_add_u32 s82, s82, 458752
    ds_write_b128 v4, v[76:79] offset:8704
    s_mov_b64 exec, 1
    ds_add_rtn_u32 v1, v17, v1 offset:536
    s_mov_b64 exec, -1
    ds_read_b32 v44, v6 offset:8704
    ds_read_b32 v45, v6 offset:8960
    ds_read_b32 v46, v6 offset:9216
    ds_read_b32 v47, v6 offset:9472
    ds_read_b32 v48, v6 offset:9728
    ds_read_b32 v49, v6 offset:9984
    ds_read_b32 v50, v6 offset:10240
    ds_read_b32 v51, v6 offset:10496
    s_waitcnt lgkmcnt(8)
    v_readfirstlane_b32 s78, v1
    s_cmp_lg_u32 s78, 3
    s_cbranch_scc1 L_e_done
    s_waitcnt lgkmcnt(4)
    v_add_f32 v44, v44, v45
    v_add_f32 v46, v46, v47
    s_waitcnt lgkmcnt(0)
    v_add_f32 v48, v48, v49
    v_add_f32 v50, v50, v51
    v_add_f32 v44, v44, v46
    v_add_f32 v48, v48, v50
    v_add_f32 v22, v44, v48
    v_perm_b32 v22, v22, v107, s101
    buffer_store_dword v22, v6, s[40:43], s82 offen sc1
L_e_done:
L_end:
    s_endpgm
L_c_pre:
    s_lshl_b32 s63, s29, 2
    s_add_u32 s63, s63, s14
    s_sub_u32 s63, s63, 11
    s_lshr_b32 s82, s29, 1
    s_add_u32 s82, s82, 64
    s_bitcmp1_b32 s29, 0
    s_cselect_b32 s83, -1, s82
    s_cselect_b32 s82, s82, -1
    s_cmp_eq_u32 s14, 15
    s_cselect_b32 s63, s83, s63
    s_cmp_lt_u32 s14, 11
    s_cselect_b32 s63, -1, s63
    s_lshr_b32 s83, s30, 2
    s_cmp_eq_u32 s83, 0
    s_cselect_b32 s82, s82, -1
    s_lshl_b32 s62, s29, 2
    s_add_u32 s62, s62, s83
    s_cmp_ge_u32 s31, 2
    s_cselect_b32 s62, s82, s62
    s_bitcmp1_b32 s31, 0
    s_cselect_b64 s[56:57], s[18:19], s[16:17]
    s_mov_b32 s58, 5308416
    s_mov_b32 s59, 0x20000
    s_mov_b64 s[64:65], s[20:21]
    s_mov_b32 s66, 5308416
    s_mov_b32 s67, 0x20000
    v_lshrrev_b32 v4, 3, v0
    v_and_b32 v5, 7, v0
    v_lshlrev_b32 v5, 4, v5
    v_mul_u32_u24 v22, 0x2400, v4
    v_add_u32 v22, v22, v5
    v_mul_u32_u24 v23, 0x480, v4
    v_add_u32 v23, v23, v5
    s_lshl_b32 s32, s63, 2
    s_add_u32 s32, s32, s31
    s_mul_i32 s32, s32, 18432
    s_add_u32 s33, s32, 9216
    s_cmp_lt_i32 s62, 0
    s_cbranch_scc1 L_c_pre_x
    s_and_b32 s82, s30, 3
    s_mul_i32 s82, s82, 1327104
    s_lshl_b32 s83, s62, 7
    s_add_u32 s82, s82, s83
    buffer_load_dwordx4 v[28:31], v22, s[56:59], s82 offen nt
    s_add_u32 s82, s82, 73728
    buffer_load_dwordx4 v[32:35], v22, s[56:59], s82 offen nt
    s_add_u32 s82, s82, 73728
    buffer_load_dwordx4 v[36:39], v22, s[56:59], s82 offen nt
    s_add_u32 s82, s82, 73728
    buffer_load_dwordx4 v[40:43], v22, s[56:59], s82 offen nt
    s_add_u32 s82, s82, 73728
    buffer_load_dwordx4 v[44:47], v22, s[56:59], s82 offen nt
    s_add_u32 s82, s82, 73728
    buffer_load_dwordx4 v[48:51], v22, s[56:59], s82 offen nt
    s_add_u32 s82, s82, 73728
    buffer_load_dwordx4 v[52:55], v22, s[56:59], s82 offen nt
    s_add_u32 s82, s82, 73728
    buffer_load_dwordx4 v[56:59], v22, s[56:59], s82 offen nt
    s_add_u32 s82, s82, 73728
    s_waitcnt vmcnt(7)
    buffer_load_dwordx4 v[60:63], v22, s[56:59], s82 offen nt
    s_add_u32 s82, s82, 73728
    s_waitcnt vmcnt(7)
    buffer_load_dwordx4 v[64:67], v22, s[56:59], s82 offen nt
    s_add_u32 s82, s82, 73728
    s_waitcnt vmcnt(7)
    buffer_load_dwordx4 v[68:71], v22, s[56:59], s82 offen nt
    s_add_u32 s82, s82, 73728
    s_waitcnt vmcnt(7)
    buffer_load_dwordx4 v[72:75], v22, s[56:59], s82 offen nt
    s_add_u32 s82, s82, 73728
    s_waitcnt vmcnt(7)
    buffer_load_dwordx4 v[76:79], v22, s[56:59], s82 offen nt
    s_add_u32 s82, s82, 73728
    s_waitcnt vmcnt(7)
    buffer_load_dwordx4 v[80:83], v22, s[56:59], s82 offen nt
    s_add_u32 s82, s82, 73728
    s_waitcnt vmcnt(7)
    buffer_load_dwordx4 v[108:111], v22, s[56:59], s82 offen nt
    s_add_u32 s82, s82, 73728
    s_waitcnt vmcnt(7)
    buffer_load_dwordx4 v[112:115], v22, s[56:59], s82 offen nt
    s_add_u32 s82, s82, 73728
    s_waitcnt vmcnt(7)
    buffer_load_dwordx4 v[116:119], v22, s[56:59], s82 offen nt
    s_add_u32 s82, s82, 73728
    s_waitcnt vmcnt(7)
    buffer_load_dwordx4 v[120:123], v22, s[56:59], s82 offen nt
L_c_pre_x:
    s_mov_b64 exec, 1
    v_mov_b32 v1, 1
    ds_add_u32 v17, v1 offset:548
    s_mov_b64 exec, -1
    v_and_b32 v1, 1, v0
    v_lshlrev_b32 v1, 4, v1
    v_mov_b32 v4, 0xffff
    v_lshlrev_b32 v4, v1, v4
    v_bfe_u32 v5, v0, 1, 2
    v_cmp_eq_u32 vcc, 0, v5
    s_nop 1
    v_cndmask_b32 v8, 0, v4, vcc
    v_cmp_eq_u32 vcc, 1, v5
    s_nop 1
    v_cndmask_b32 v9, 0, v4, vcc
    v_cmp_eq_u32 vcc, 2, v5
    s_nop 1
    v_cndmask_b32 v10, 0, v4, vcc
    v_cmp_eq_u32 vcc, 3, v5
    s_nop 1
    v_cndmask_b32 v11, 0, v4, vcc
    v_bfe_u32 v4, v0, 4, 1
    v_and_b32 v5, 7, v0
    v_lshl_add_u32 v4, v4, 3, v5
    v_lshlrev_b32 v105, 4, v4
    s_waitcnt lgkmcnt(0)
    s_add_u32 s82, s100, 0x9e3779b9
    v_mov_b32 v107, s82
    s_mov_b32 s101, 0x07060500
    s_cmp_lt_i32 s62, 0
    s_cbranch_scc1 L_cons_main
L_gu_x:
    ds_read_b32 v1, v17 offset:544
    s_waitcnt lgkmcnt(0)
    v_cmp_eq_u32 vcc, 1, v1
    s_cbranch_vccnz L_gu_x_ok
    s_sub_u32 s3, s3, 1
    s_cbranch_scc0 L_gu_x
    s_endpgm
L_gu_x_ok:
    v_lshlrev_b32 v4, 2, v0
    ds_read_b32 v149, v4 offset:1536
    ds_read_b32 v150, v4 offset:1792
    ds_read_b32 v151, v4 offset:2048
    s_waitcnt lgkmcnt(0)
    v_mov_b32_dpp v7, v149 row_newbcast:0 row_mask:0xf bank_mask:0x3
    s_nop 1
    v_mov_b32_dpp v7, v149 row_newbcast:8 row_mask:0xf bank_mask:0xc
    v_and_b32 v84, v7, v8
    v_and_b32 v85, v7, v9
    v_and_b32 v86, v7, v10
    v_and_b32 v87, v7, v11
    s_waitcnt vmcnt(17)
    s_nop 0
    v_mfma_f32_16x16x32_bf16 v[92:95], v[28:31], v[84:87], 0
    v_mov_b32_dpp v7, v149 row_newbcast:1 row_mask:0xf bank_mask:0x3
    s_nop 1
    v_mov_b32_dpp v7, v149 row_newbcast:9 row_mask:0xf bank_mask:0xc
    v_and_b32 v88, v7, v8
    v_and_b32 v89, v7, v9
    v_and_b32 v90, v7, v10
    v_and_b32 v91, v7, v11
    s_waitcnt vmcnt(16)
    s_nop 0
    v_mfma_f32_16x16x32_bf16 v[92:95], v[32:35], v[88:91], v[92:95]
    v_mov_b32_dpp v7, v149 row_newbcast:2 row_mask:0xf bank_mask:0x3
    s_nop 1
    v_mov_b32_dpp v7, v149 row_newbcast:10 row_mask:0xf bank_mask:0xc
    v_and_b32 v84, v7, v8
    v_and_b32 v85, v7, v9
    v_and_b32 v86, v7, v10
    v_and_b32 v87, v7, v11
    s_waitcnt vmcnt(15)
    s_nop 0
    v_mfma_f32_16x16x32_bf16 v[92:95], v[36:39], v[84:87], v[92:95]
    v_mov_b32_dpp v7, v149 row_newbcast:3 row_mask:0xf bank_mask:0x3
    s_nop 1
    v_mov_b32_dpp v7, v149 row_newbcast:11 row_mask:0xf bank_mask:0xc
    v_and_b32 v88, v7, v8
    v_and_b32 v89, v7, v9
    v_and_b32 v90, v7, v10
    v_and_b32 v91, v7, v11
    s_waitcnt vmcnt(14)
    s_nop 0
    v_mfma_f32_16x16x32_bf16 v[92:95], v[40:43], v[88:91], v[92:95]
    v_mov_b32_dpp v7, v149 row_newbcast:4 row_mask:0xf bank_mask:0x3
    s_nop 1
    v_mov_b32_dpp v7, v149 row_newbcast:12 row_mask:0xf bank_mask:0xc
    v_and_b32 v84, v7, v8
    v_and_b32 v85, v7, v9
    v_and_b32 v86, v7, v10
    v_and_b32 v87, v7, v11
    s_waitcnt vmcnt(13)
    s_nop 0
    v_mfma_f32_16x16x32_bf16 v[92:95], v[44:47], v[84:87], v[92:95]
    v_mov_b32_dpp v7, v149 row_newbcast:5 row_mask:0xf bank_mask:0x3
    s_nop 1
    v_mov_b32_dpp v7, v149 row_newbcast:13 row_mask:0xf bank_mask:0xc
    v_and_b32 v88, v7, v8
    v_and_b32 v89, v7, v9
    v_and_b32 v90, v7, v10
    v_and_b32 v91, v7, v11
    s_waitcnt vmcnt(12)
    s_nop 0
    v_mfma_f32_16x16x32_bf16 v[92:95], v[48:51], v[88:91], v[92:95]
    v_mov_b32_dpp v7, v149 row_newbcast:6 row_mask:0xf bank_mask:0x3
    s_nop 1
    v_mov_b32_dpp v7, v149 row_newbcast:14 row_mask:0xf bank_mask:0xc
    v_and_b32 v84, v7, v8
    v_and_b32 v85, v7, v9
    v_and_b32 v86, v7, v10
    v_and_b32 v87, v7, v11
    s_waitcnt vmcnt(11)
    s_nop 0
    v_mfma_f32_16x16x32_bf16 v[92:95], v[52:55], v[84:87], v[92:95]
    v_mov_b32_dpp v7, v149 row_newbcast:7 row_mask:0xf bank_mask:0x3
    s_nop 1
    v_mov_b32_dpp v7, v149 row_newbcast:15 row_mask:0xf bank_mask:0xc
    v_and_b32 v88, v7, v8
    v_and_b32 v89, v7, v9
    v_and_b32 v90, v7, v10
    v_and_b32 v91, v7, v11
    s_waitcnt vmcnt(10)
    s_nop 0
    v_mfma_f32_16x16x32_bf16 v[92:95], v[56:59], v[88:91], v[92:95]
    v_mov_b32_dpp v7, v150 row_newbcast:0 row_mask:0xf bank_mask:0x3
    s_nop 1
    v_mov_b32_dpp v7, v150 row_newbcast:8 row_mask:0xf bank_mask:0xc
    v_and_b32 v84, v7, v8
    v_and_b32 v85, v7, v9
    v_and_b32 v86, v7, v10
    v_and_b32 v87, v7, v11
    s_waitcnt vmcnt(9)
    s_nop 0
    v_mfma_f32_16x16x32_bf16 v[92:95], v[60:63], v[84:87], v[92:95]
    v_mov_b32_dpp v7, v150 row_newbcast:1 row_mask:0xf bank_mask:0x3
    s_nop 1
    v_mov_b32_dpp v7, v150 row_newbcast:9 row_mask:0xf bank_mask:0xc
    v_and_b32 v88, v7, v8
    v_and_b32 v89, v7, v9
    v_and_b32 v90, v7, v10
    v_and_b32 v91, v7, v11
    s_waitcnt vmcnt(8)
    s_nop 0
    v_mfma_f32_16x16x32_bf16 v[92:95], v[64:67], v[88:91], v[92:95]
    v_mov_b32_dpp v7, v150 row_newbcast:2 row_mask:0xf bank_mask:0x3
    s_nop 1
    v_mov_b32_dpp v7, v150 row_newbcast:10 row_mask:0xf bank_mask:0xc
    v_and_b32 v84, v7, v8
    v_and_b32 v85, v7, v9
    v_and_b32 v86, v7, v10
    v_and_b32 v87, v7, v11
    s_waitcnt vmcnt(7)
    s_nop 0
    v_mfma_f32_16x16x32_bf16 v[92:95], v[68:71], v[84:87], v[92:95]
    v_mov_b32_dpp v7, v150 row_newbcast:3 row_mask:0xf bank_mask:0x3
    s_nop 1
    v_mov_b32_dpp v7, v150 row_newbcast:11 row_mask:0xf bank_mask:0xc
    v_and_b32 v88, v7, v8
    v_and_b32 v89, v7, v9
    v_and_b32 v90, v7, v10
    v_and_b32 v91, v7, v11
    s_waitcnt vmcnt(6)
    s_nop 0
    v_mfma_f32_16x16x32_bf16 v[92:95], v[72:75], v[88:91], v[92:95]
    v_mov_b32_dpp v7, v150 row_newbcast:4 row_mask:0xf bank_mask:0x3
    s_nop 1
    v_mov_b32_dpp v7, v150 row_newbcast:12 row_mask:0xf bank_mask:0xc
    v_and_b32 v84, v7, v8
    v_and_b32 v85, v7, v9
    v_and_b32 v86, v7, v10
    v_and_b32 v87, v7, v11
    s_waitcnt vmcnt(5)
    s_nop 0
    v_mfma_f32_16x16x32_bf16 v[92:95], v[76:79], v[84:87], v[92:95]
    v_mov_b32_dpp v7, v150 row_newbcast:5 row_mask:0xf bank_mask:0x3
    s_nop 1
    v_mov_b32_dpp v7, v150 row_newbcast:13 row_mask:0xf bank_mask:0xc
    v_and_b32 v88, v7, v8
    v_and_b32 v89, v7, v9
    v_and_b32 v90, v7, v10
    v_and_b32 v91, v7, v11
    s_waitcnt vmcnt(4)
    s_nop 0
    v_mfma_f32_16x16x32_bf16 v[92:95], v[80:83], v[88:91], v[92:95]
    v_mov_b32_dpp v7, v150 row_newbcast:6 row_mask:0xf bank_mask:0x3
    s_nop 1
    v_mov_b32_dpp v7, v150 row_newbcast:14 row_mask:0xf bank_mask:0xc
    v_and_b32 v84, v7, v8
    v_and_b32 v85, v7, v9
    v_and_b32 v86, v7, v10
    v_and_b32 v87, v7, v11
    s_waitcnt vmcnt(3)
    s_nop 0
    v_mfma_f32_16x16x32_bf16 v[92:95], v[108:111], v[84:87], v[92:95]
    v_mov_b32_dpp v7, v150 row_newbcast:7 row_mask:0xf bank_mask:0x3
    s_nop 1
    v_mov_b32_dpp v7, v150 row_newbcast:15 row_mask:0xf bank_mask:0xc
    v_and_b32 v88, v7, v8
    v_and_b32 v89, v7, v9
    v_and_b32 v90, v7, v10
    v_and_b32 v91, v7, v11
    s_waitcnt vmcnt(2)
    s_nop 0
    v_mfma_f32_16x16x32_bf16 v[92:95], v[112:115], v[88:91], v[92:95]
    v_mov_b32_dpp v7, v151 row_newbcast:0 row_mask:0xf bank_mask:0x3
    s_nop 1
    v_mov_b32_dpp v7, v151 row_newbcast:8 row_mask:0xf bank_mask:0xc
    v_and_b32 v84, v7, v8
    v_and_b32 v85, v7, v9
    v_and_b32 v86, v7, v10
    v_and_b32 v87, v7, v11
    s_waitcnt vmcnt(1)
    s_nop 0
    v_mfma_f32_16x16x32_bf16 v[92:95], v[116:119], v[84:87], v[92:95]
    v_mov_b32_dpp v7, v151 row_newbcast:1 row_mask:0xf bank_mask:0x3
    s_nop 1
    v_mov_b32_dpp v7, v151 row_newbcast:9 row_mask:0xf bank_mask:0xc
    v_and_b32 v88, v7, v8
    v_and_b32 v89, v7, v9
    v_and_b32 v90, v7, v10
    v_and_b32 v91, v7, v11
    s_waitcnt vmcnt(0)
    s_nop 0
    v_mfma_f32_16x16x32_bf16 v[92:95], v[120:123], v[88:91], v[92:95]
    s_lshl_b32 s82, s62, 11
    s_and_b32 s83, s30, 3
    s_lshl_b32 s83, s83, 9
    s_add_u32 s82, s82, s83
    s_and_b32 s83, s31, 1
    s_lshl_b32 s83, s83, 8
    s_add_u32 s82, s82, s83
    s_add_u32 s82, s82, 720896
    v_mov_b32_dpp v44, v92 row_ror:8 row_mask:0xf bank_mask:0xf
    v_mov_b32_dpp v45, v93 row_ror:8 row_mask:0xf bank_mask:0xf
    v_mov_b32_dpp v46, v94 row_ror:8 row_mask:0xf bank_mask:0xf
    v_mov_b32_dpp v47, v95 row_ror:8 row_mask:0xf bank_mask:0xf
    s_nop 0
    v_permlane32_swap_b32 v44, v48
    v_permlane32_swap_b32 v45, v49
    v_permlane32_swap_b32 v46, v50
    v_permlane32_swap_b32 v47, v51
    v_add_f32 v92, v92, v48
    v_add_f32 v93, v93, v49
    v_add_f32 v94, v94, v50
    v_add_f32 v95, v95, v51
    v_bfi_b32 v92, 15, v107, v92
    v_bfi_b32 v93, 15, v107, v93
    v_bfi_b32 v94, 15, v107, v94
    v_bfi_b32 v95, 15, v107, v95
    s_mov_b64 exec, 0x00ff00ff
    buffer_store_dwordx4 v[92:95], v105, s[40:43], s82 offen sc1
    s_mov_b64 exec, -1
    s_branch L_cons_main
L_c_wd:
    buffer_load_dwordx4 v[152:155], v150, s[64:67], s32 offen offset:0 nt
    buffer_load_dwordx4 v[156:159], v150, s[64:67], s32 offen offset:128 nt
    buffer_load_dwordx4 v[160:163], v150, s[64:67], s32 offen offset:256 nt
    buffer_load_dwordx4 v[164:167], v150, s[64:67], s32 offen offset:384 nt
    buffer_load_dwordx4 v[168:171], v150, s[64:67], s32 offen offset:512 nt
    buffer_load_dwordx4 v[172:175], v150, s[64:67], s32 offen offset:640 nt
    buffer_load_dwordx4 v[176:179], v150, s[64:67], s32 offen offset:768 nt
    buffer_load_dwordx4 v[180:183], v150, s[64:67], s32 offen offset:896 nt
    buffer_load_dwordx4 v[184:187], v150, s[64:67], s32 offen offset:1024 nt
    buffer_load_dwordx4 v[188:191], v150, s[64:67], s33 offen offset:0 nt
    buffer_load_dwordx4 v[192:195], v150, s[64:67], s33 offen offset:128 nt
    buffer_load_dwordx4 v[196:199], v150, s[64:67], s33 offen offset:256 nt
    buffer_load_dwordx4 v[200:203], v150, s[64:67], s33 offen offset:384 nt
    buffer_load_dwordx4 v[204:207], v150, s[64:67], s33 offen offset:512 nt
    buffer_load_dwordx4 v[208:211], v150, s[64:67], s33 offen offset:640 nt
    buffer_load_dwordx4 v[212:215], v150, s[64:67], s33 offen offset:768 nt
    buffer_load_dwordx4 v[216:219], v150, s[64:67], s33 offen offset:896 nt
    buffer_load_dwordx4 v[220:223], v150, s[64:67], s33 offen offset:1024 nt
    s_branch L_k
L_c_down:
    v_and_b32 v4, 1, v0
    s_lshl_b32 s82, s31, 1
    v_add_u32 v4, s82, v4
    v_lshrrev_b32 v5, 2, v4
    v_and_b32 v4, 3, v4
    v_lshl_add_u32 v4, v5, 5, v4
    v_lshrrev_b32 v5, 3, v0
    v_lshl_add_u32 v4, v5, 2, v4
    v_lshlrev_b32 v4, 2, v4
    s_lshl_b32 s82, s63, 11
    s_add_u32 s82, s82, 720896
L_dn_poll:
    buffer_load_dword v44, v4, s[40:43], s82 offen offset:0 sc1
    buffer_load_dword v45, v4, s[40:43], s82 offen offset:256 sc1
    buffer_load_dword v46, v4, s[40:43], s82 offen offset:512 sc1
    buffer_load_dword v47, v4, s[40:43], s82 offen offset:768 sc1
    buffer_load_dword v48, v4, s[40:43], s82 offen offset:1024 sc1
    buffer_load_dword v49, v4, s[40:43], s82 offen offset:1280 sc1
    buffer_load_dword v50, v4, s[40:43], s82 offen offset:1536 sc1
    buffer_load_dword v51, v4, s[40:43], s82 offen offset:1792 sc1
    s_waitcnt vmcnt(0)
    v_bitop3_b32 v1, v44, v45, v107 bitop3:0x7e
    v_bitop3_b32 v1, v1, v46, v107 bitop3:0xf6
    v_bitop3_b32 v1, v1, v47, v107 bitop3:0xf6
    v_bitop3_b32 v1, v1, v48, v107 bitop3:0xf6
    v_bitop3_b32 v1, v1, v49, v107 bitop3:0xf6
    v_bitop3_b32 v1, v1, v50, v107 bitop3:0xf6
    v_bitop3_b32 v1, v1, v51, v107 bitop3:0xf6
    v_and_b32 v1, 15, v1
    v_cmp_ne_u32 vcc, 0, v1
    s_cbranch_vccz L_dn_ok
    s_sleep 2
    s_sub_u32 s3, s3, 1
    s_cbranch_scc0 L_dn_poll
    s_endpgm
L_dn_ok:
    v_add_f32 v44, v44, v46
    v_add_f32 v48, v48, v50
    v_add_f32 v44, v44, v48
    v_add_f32 v45, v45, v47
    v_add_f32 v49, v49, v51
    v_add_f32 v45, v45, v49
    v_cvt_pk_bf16_f32 v44, 0, v44
    v_cvt_pk_bf16_f32 v45, 0, v45
    v_mul_f32 v44, 0xbfb8aa3b, v44
    v_exp_f32 v44, v44
    s_nop 0
    v_add_f32 v44, 1.0, v44
    v_rcp_f32 v44, v44
    s_nop 0
    v_cvt_pk_bf16_f32 v44, 0, v44
    v_mul_f32 v44, v44, v45
    v_cvt_pk_bf16_f32 v149, v44, v44
    s_nop 1
    v_mov_b32_dpp v7, v149 row_newbcast:0 row_mask:0xf bank_mask:0x3
    s_nop 1
    v_mov_b32_dpp v7, v149 row_newbcast:8 row_mask:0xf bank_mask:0xc
    v_and_b32 v84, v7, v8
    v_and_b32 v85, v7, v9
    v_and_b32 v86, v7, v10
    v_and_b32 v87, v7, v11
    s_nop 1
    v_mfma_f32_16x16x32_bf16 v[108:111], v[152:155], v[84:87], 0
    v_mfma_f32_16x16x32_bf16 v[112:115], v[156:159], v[84:87], 0
    v_mfma_f32_16x16x32_bf16 v[116:119], v[160:163], v[84:87], 0
    v_mfma_f32_16x16x32_bf16 v[120:123], v[164:167], v[84:87], 0
    v_mfma_f32_16x16x32_bf16 v[124:127], v[168:171], v[84:87], 0
    v_mfma_f32_16x16x32_bf16 v[128:131], v[172:175], v[84:87], 0
    v_mfma_f32_16x16x32_bf16 v[132:135], v[176:179], v[84:87], 0
    v_mfma_f32_16x16x32_bf16 v[136:139], v[180:183], v[84:87], 0
    v_mfma_f32_16x16x32_bf16 v[92:95], v[184:187], v[84:87], 0
    v_mov_b32_dpp v7, v149 row_newbcast:1 row_mask:0xf bank_mask:0x3
    s_nop 1
    v_mov_b32_dpp v7, v149 row_newbcast:9 row_mask:0xf bank_mask:0xc
    v_and_b32 v88, v7, v8
    v_and_b32 v89, v7, v9
    v_and_b32 v90, v7, v10
    v_and_b32 v91, v7, v11
    s_nop 1
    v_mfma_f32_16x16x32_bf16 v[108:111], v[188:191], v[88:91], v[108:111]
    v_mfma_f32_16x16x32_bf16 v[112:115], v[192:195], v[88:91], v[112:115]
    v_mfma_f32_16x16x32_bf16 v[116:119], v[196:199], v[88:91], v[116:119]
    v_mfma_f32_16x16x32_bf16 v[120:123], v[200:203], v[88:91], v[120:123]
    v_mfma_f32_16x16x32_bf16 v[124:127], v[204:207], v[88:91], v[124:127]
    v_mfma_f32_16x16x32_bf16 v[128:131], v[208:211], v[88:91], v[128:131]
    v_mfma_f32_16x16x32_bf16 v[132:135], v[212:215], v[88:91], v[132:135]
    v_mfma_f32_16x16x32_bf16 v[136:139], v[216:219], v[88:91], v[136:139]
    v_mfma_f32_16x16x32_bf16 v[92:95], v[220:223], v[88:91], v[92:95]
    s_mul_i32 s82, s31, 2304
    s_add_u32 s82, s82, 10240
    v_add_u32 v4, s82, v105
    v_mov_b32_dpp v44, v108 row_ror:8 row_mask:0xf bank_mask:0xf
    v_mov_b32_dpp v45, v109 row_ror:8 row_mask:0xf bank_mask:0xf
    v_mov_b32_dpp v46, v110 row_ror:8 row_mask:0xf bank_mask:0xf
    v_mov_b32_dpp v47, v111 row_ror:8 row_mask:0xf bank_mask:0xf
    s_nop 0
    v_permlane32_swap_b32 v44, v48
    v_permlane32_swap_b32 v45, v49
    v_permlane32_swap_b32 v46, v50
    v_permlane32_swap_b32 v47, v51
    v_add_f32 v108, v108, v48
    v_add_f32 v109, v109, v49
    v_add_f32 v110, v110, v50
    v_add_f32 v111, v111, v51
    v_mov_b32_dpp v44, v112 row_ror:8 row_mask:0xf bank_mask:0xf
    v_mov_b32_dpp v45, v113 row_ror:8 row_mask:0xf bank_mask:0xf
    v_mov_b32_dpp v46, v114 row_ror:8 row_mask:0xf bank_mask:0xf
    v_mov_b32_dpp v47, v115 row_ror:8 row_mask:0xf bank_mask:0xf
    s_nop 0
    v_permlane32_swap_b32 v44, v48
    v_permlane32_swap_b32 v45, v49
    v_permlane32_swap_b32 v46, v50
    v_permlane32_swap_b32 v47, v51
    v_add_f32 v112, v112, v48
    v_add_f32 v113, v113, v49
    v_add_f32 v114, v114, v50
    v_add_f32 v115, v115, v51
    v_mov_b32_dpp v44, v116 row_ror:8 row_mask:0xf bank_mask:0xf
    v_mov_b32_dpp v45, v117 row_ror:8 row_mask:0xf bank_mask:0xf
    v_mov_b32_dpp v46, v118 row_ror:8 row_mask:0xf bank_mask:0xf
    v_mov_b32_dpp v47, v119 row_ror:8 row_mask:0xf bank_mask:0xf
    s_nop 0
    v_permlane32_swap_b32 v44, v48
    v_permlane32_swap_b32 v45, v49
    v_permlane32_swap_b32 v46, v50
    v_permlane32_swap_b32 v47, v51
    v_add_f32 v116, v116, v48
    v_add_f32 v117, v117, v49
    v_add_f32 v118, v118, v50
    v_add_f32 v119, v119, v51
    v_mov_b32_dpp v44, v120 row_ror:8 row_mask:0xf bank_mask:0xf
    v_mov_b32_dpp v45, v121 row_ror:8 row_mask:0xf bank_mask:0xf
    v_mov_b32_dpp v46, v122 row_ror:8 row_mask:0xf bank_mask:0xf
    v_mov_b32_dpp v47, v123 row_ror:8 row_mask:0xf bank_mask:0xf
    s_nop 0
    v_permlane32_swap_b32 v44, v48
    v_permlane32_swap_b32 v45, v49
    v_permlane32_swap_b32 v46, v50
    v_permlane32_swap_b32 v47, v51
    v_add_f32 v120, v120, v48
    v_add_f32 v121, v121, v49
    v_add_f32 v122, v122, v50
    v_add_f32 v123, v123, v51
    v_mov_b32_dpp v44, v124 row_ror:8 row_mask:0xf bank_mask:0xf
    v_mov_b32_dpp v45, v125 row_ror:8 row_mask:0xf bank_mask:0xf
    v_mov_b32_dpp v46, v126 row_ror:8 row_mask:0xf bank_mask:0xf
    v_mov_b32_dpp v47, v127 row_ror:8 row_mask:0xf bank_mask:0xf
    s_nop 0
    v_permlane32_swap_b32 v44, v48
    v_permlane32_swap_b32 v45, v49
    v_permlane32_swap_b32 v46, v50
    v_permlane32_swap_b32 v47, v51
    v_add_f32 v124, v124, v48
    v_add_f32 v125, v125, v49
    v_add_f32 v126, v126, v50
    v_add_f32 v127, v127, v51
    v_mov_b32_dpp v44, v128 row_ror:8 row_mask:0xf bank_mask:0xf
    v_mov_b32_dpp v45, v129 row_ror:8 row_mask:0xf bank_mask:0xf
    v_mov_b32_dpp v46, v130 row_ror:8 row_mask:0xf bank_mask:0xf
    v_mov_b32_dpp v47, v131 row_ror:8 row_mask:0xf bank_mask:0xf
    s_nop 0
    v_permlane32_swap_b32 v44, v48
    v_permlane32_swap_b32 v45, v49
    v_permlane32_swap_b32 v46, v50
    v_permlane32_swap_b32 v47, v51
    v_add_f32 v128, v128, v48
    v_add_f32 v129, v129, v49
    v_add_f32 v130, v130, v50
    v_add_f32 v131, v131, v51
    v_mov_b32_dpp v44, v132 row_ror:8 row_mask:0xf bank_mask:0xf
    v_mov_b32_dpp v45, v133 row_ror:8 row_mask:0xf bank_mask:0xf
    v_mov_b32_dpp v46, v134 row_ror:8 row_mask:0xf bank_mask:0xf
    v_mov_b32_dpp v47, v135 row_ror:8 row_mask:0xf bank_mask:0xf
    s_nop 0
    v_permlane32_swap_b32 v44, v48
    v_permlane32_swap_b32 v45, v49
    v_permlane32_swap_b32 v46, v50
    v_permlane32_swap_b32 v47, v51
    v_add_f32 v132, v132, v48
    v_add_f32 v133, v133, v49
    v_add_f32 v134, v134, v50
    v_add_f32 v135, v135, v51
    v_mov_b32_dpp v44, v136 row_ror:8 row_mask:0xf bank_mask:0xf
    v_mov_b32_dpp v45, v137 row_ror:8 row_mask:0xf bank_mask:0xf
    v_mov_b32_dpp v46, v138 row_ror:8 row_mask:0xf bank_mask:0xf
    v_mov_b32_dpp v47, v139 row_ror:8 row_mask:0xf bank_mask:0xf
    s_nop 0
    v_permlane32_swap_b32 v44, v48
    v_permlane32_swap_b32 v45, v49
    v_permlane32_swap_b32 v46, v50
    v_permlane32_swap_b32 v47, v51
    v_add_f32 v136, v136, v48
    v_add_f32 v137, v137, v49
    v_add_f32 v138, v138, v50
    v_add_f32 v139, v139, v51
    v_mov_b32_dpp v44, v92 row_ror:8 row_mask:0xf bank_mask:0xf
    v_mov_b32_dpp v45, v93 row_ror:8 row_mask:0xf bank_mask:0xf
    v_mov_b32_dpp v46, v94 row_ror:8 row_mask:0xf bank_mask:0xf
    v_mov_b32_dpp v47, v95 row_ror:8 row_mask:0xf bank_mask:0xf
    s_nop 0
    v_permlane32_swap_b32 v44, v48
    v_permlane32_swap_b32 v45, v49
    v_permlane32_swap_b32 v46, v50
    v_permlane32_swap_b32 v47, v51
    v_add_f32 v92, v92, v48
    v_add_f32 v93, v93, v49
    v_add_f32 v94, v94, v50
    v_add_f32 v95, v95, v51
    s_mov_b64 exec, 0x00ff00ff
    ds_write_b128 v4, v[108:111] offset:0
    ds_write_b128 v4, v[112:115] offset:256
    ds_write_b128 v4, v[116:119] offset:512
    ds_write_b128 v4, v[120:123] offset:768
    ds_write_b128 v4, v[124:127] offset:1024
    ds_write_b128 v4, v[128:131] offset:1280
    ds_write_b128 v4, v[132:135] offset:1536
    ds_write_b128 v4, v[136:139] offset:1792
    ds_write_b128 v4, v[92:95] offset:2048
    s_mov_b64 exec, 1
    v_mov_b32 v1, 1
    ds_add_u32 v17, v1 offset:552
    s_mov_b64 exec, -1
    s_cmp_eq_u32 s31, 3
    s_cbranch_scc1 L_k_on
L_dn_j:
    ds_read_b32 v1, v17 offset:552
    s_waitcnt lgkmcnt(0)
    v_cmp_eq_u32 vcc, 4, v1
    s_cbranch_vccnz L_dn_j_ok
    s_sub_u32 s3, s3, 1
    s_cbranch_scc0 L_dn_j
    s_endpgm
L_dn_j_ok:
    s_lshl_b32 s64, s31, 6
    v_add_u32 v4, s64, v0
    v_cmp_gt_u32 vcc, 0x90, v4
    s_and_saveexec_b64 s[82:83], vcc
    v_lshlrev_b32 v5, 4, v4
    v_add_u32 v5, 10240, v5
    ds_read_b128 v[44:47], v5 offset:0
    ds_read_b128 v[48:51], v5 offset:2304
    ds_read_b128 v[52:55], v5 offset:4608
    ds_read_b128 v[56:59], v5 offset:6912
    v_lshrrev_b32 v5, 4, v4
    v_mul_u32_u24 v5, 18432, v5
    v_and_b32 v4, 15, v4
    v_lshl_add_u32 v4, v4, 4, v5
    s_lshl_b32 s64, s63, 8
    s_add_u32 s64, s64, 524288
    s_waitcnt lgkmcnt(0)
    v_add_f32 v44, v44, v48
    v_add_f32 v45, v45, v49
    v_add_f32 v46, v46, v50
    v_add_f32 v47, v47, v51
    v_add_f32 v44, v44, v52
    v_add_f32 v45, v45, v53
    v_add_f32 v46, v46, v54
    v_add_f32 v47, v47, v55
    v_add_f32 v44, v44, v56
    v_add_f32 v45, v45, v57
    v_add_f32 v46, v46, v58
    v_add_f32 v47, v47, v59
    v_perm_b32 v44, v44, v107, s101
    v_perm_b32 v45, v45, v107, s101
    v_perm_b32 v46, v46, v107, s101
    v_perm_b32 v47, v47, v107, s101
    buffer_store_dwordx4 v[44:47], v4, s[40:43], s64 offen sc1
    s_mov_b64 exec, -1
    s_branch L_k_on
L_code_end:
    s_endpgm
    .fill 64, 4, 0xbf800000
.section .rodata,"a"
.p2align 6
.amdhsa_kernel recurrent_scan__gqa_block_cached__glu_gated_glu__decode_kernel
  .amdhsa_next_free_vgpr 228
  .amdhsa_next_free_sgpr 102
  .amdhsa_accum_offset 228
  .amdhsa_group_segment_fixed_size 0
  .amdhsa_kernarg_size 96
  .amdhsa_user_sgpr_count 2
  .amdhsa_user_sgpr_kernarg_segment_ptr 1
  .amdhsa_system_sgpr_workgroup_id_x 1
  .amdhsa_float_denorm_mode_32 3
.end_amdhsa_kernel
```
